```python
import torch

def _softmax(x, axis=-1):
    return torch.softmax(x, dim=axis)
def _gelu(x):
    return torch.nn.functional.gelu(x, approximate="tanh")
def _silu(x):
    return torch.nn.functional.silu(x)
def _sigmoid(x):
    return torch.sigmoid(x)
def _layernorm(x, axis=-1, eps=1e-5):
    m = x.mean(dim=axis, keepdim=True)
    v = x.var(dim=axis, keepdim=True, unbiased=False)
    return (x - m) / torch.sqrt(v + eps)
def _scatter_add(tgt, idx, src, axis=0):
    return tgt.clone().index_add_(axis, idx, src)
def _segment_sum(src, seg, n):
    out = torch.zeros((n,) + src.shape[1:], dtype=src.dtype)
    return out.index_add_(0, seg, src)
def _pad(x, pw):
    flat = tuple(v for pair in reversed(pw) for v in pair)
    return torch.nn.functional.pad(x, flat)

kernel_name = 'parallel_sum__sliding_block__mixer_token_mlp__prompt'

def setup_inputs():

    _w = (lambda a: (lambda t: t.to(torch.bfloat16) if t.is_floating_point() else t)(torch.as_tensor(a)))
    def _A_setup():
        B, S, D = 1, 2048, 640
        return {
            "x": _w((lambda *s: torch.randn(*s, dtype=torch.bfloat16) * 0.05)(B, S, D)),
            "wqkv": _w((lambda *s: torch.randn(*s, dtype=torch.bfloat16) * 0.05)(D, 3 * D)),
            "wo": _w((lambda *s: torch.randn(*s, dtype=torch.bfloat16) * 0.05)(D, D)),
        }
    _A_in = _A_setup()

    def _B_setup():
        B, S, D, F = 1, 2048, 640, 1536
        return {
            "x": _w((lambda *s: torch.randn(*s, dtype=torch.bfloat16) * 0.05)(B, S, D)),
            "w1": _w((lambda *s: torch.randn(*s, dtype=torch.bfloat16) * 0.8)(S, F) * (S ** -0.5)),
            "b1": _w((lambda *s: torch.randn(*s, dtype=torch.bfloat16) * 0.8)(F) * 0.02),
            "w2": _w((lambda *s: torch.randn(*s, dtype=torch.bfloat16) * 0.8)(F, S) * (F ** -0.5)),
            "b2": _w((lambda *s: torch.randn(*s, dtype=torch.bfloat16) * 0.8)(S) * 0.02),
        }
    _B_in = _B_setup()

    return {
        "A_x": _A_in["x"],
        "A_wqkv": _A_in["wqkv"],
        "A_wo": _A_in["wo"],
        "B_x": _B_in["x"],
        "B_w1": _B_in["w1"],
        "B_b1": _B_in["b1"],
        "B_w2": _B_in["w2"],
        "B_b2": _B_in["b2"],
    }

def reference(A_x, A_wqkv, A_wo, B_x, B_w1, B_b1, B_w2, B_b2):
    def _A_ref(x, wqkv, wo):
        B, S, D = x.shape
        H = 32; Dh = D // H; W = 256
        qkv = (lambda x, *d: x.permute(*d))((x @ wqkv).reshape(B, S, 3, H, Dh), 2, 0, 3, 1, 4)
        q, k, v = qkv[0], qkv[1], qkv[2]
        scores = torch.einsum("bhqd,bhkd->bhqk", q, k) * (Dh ** -0.5)
        idx = torch.arange(S)
        mask = (idx[:, None] - idx[None, :] >= 0) & (idx[:, None] - idx[None, :] < W)
        scores = torch.where(mask[None, None], scores, -1e9)
        p = _softmax(scores, axis=-1)
        o = torch.einsum("bhqk,bhkd->bhqd", p, v)
        return (lambda x, *d: x.permute(*d))(o, 0, 2, 1, 3).reshape(B, S, D) @ wo

    def _B_ref(x, w1, b1, w2, b2):
        B, S, D = x.shape
        h = _layernorm(x, axis=-1)
        u = torch.einsum("bsd,sf->bdf", h, w1) + b1
        u = _gelu(u)
        y = torch.einsum("bdf,fs->bds", u, w2) + b2
        return (lambda x, *d: x.permute(*d))(y, 0, 2, 1)

    x = A_x
    xn = _layernorm(x, axis=-1)
    return x + _A_ref(xn, A_wqkv, A_wo) + _B_ref(xn, B_w1, B_b1, B_w2, B_b2)
```

```asm
; @launch grid=(256,1,1) block=(512,1,1) lds=163840
.amdgcn_target "amdgcn-amd-amdhsa--gfx950"
.text
.globl parallel_sum__sliding_block__mixer_token_mlp__prompt_kernel
.p2align 8
.type parallel_sum__sliding_block__mixer_token_mlp__prompt_kernel,@function
parallel_sum__sliding_block__mixer_token_mlp__prompt_kernel:
    s_cmp_ge_u32 s2, 256
    s_cbranch_scc1 parallel_sum__sliding_block__mixer_token_mlp__prompt_kernel_end
    s_load_dwordx2 s[28:29], s[0:1], 0
    s_load_dwordx2 s[32:33], s[0:1], 8
    s_load_dwordx2 s[36:37], s[0:1], 16
    s_load_dwordx2 s[40:41], s[0:1], 32
    s_load_dwordx2 s[56:57], s[0:1], 40
    s_load_dwordx2 s[44:45], s[0:1], 48
    s_load_dwordx2 s[60:61], s[0:1], 56
    s_load_dwordx2 s[52:53], s[0:1], 64
    s_load_dwordx2 s[64:65], s[0:1], 72
    s_load_dwordx2 s[48:49], s[0:1], 80
    v_lshrrev_b32 v1, 6, v0
    v_and_b32 v0, 63, v0
    s_mov_b32 s76, s2
    v_readfirstlane_b32 s68, v1
    s_and_b32 s86, s2, 7
    s_lshr_b32 s87, s2, 3
    s_and_b32 s88, s86, 1
    s_lshr_b32 s89, s86, 1
    s_and_b32 s90, s87, 7
    s_lshr_b32 s91, s87, 3
    s_lshl_b32 s70, s88, 3
    s_add_u32 s70, s70, s90
    s_lshl_b32 s71, s89, 2
    s_add_u32 s71, s71, s91
    s_lshl_b32 s74, s89, 3
    s_add_u32 s74, s74, s90
    s_lshl_b32 s75, s88, 2
    s_add_u32 s75, s75, s91
    s_cmp_lt_u32 s87, 30
    s_cselect_b32 s78, 1, 0
    s_cselect_b32 s90, 0, 30
    s_sub_u32 s87, s87, s90
    s_mul_i32 s90, s87, 52
    s_lshr_b32 s90, s90, 8
    s_mul_i32 s91, s90, 5
    s_sub_u32 s91, s87, s91
    s_mul_i32 s72, s88, 5
    s_add_u32 s72, s72, s91
    s_mul_i32 s73, s89, 6
    s_add_u32 s73, s73, s90
    s_and_b32 s69, s68, 3
    s_lshr_b32 s94, s69, 1
    s_and_b32 s95, s69, 1
    s_mov_b32 s30, 2621440
    s_mov_b32 s31, 0x00020000
    s_mov_b32 s34, 2457600
    s_mov_b32 s35, 0x00020000
    s_mov_b32 s38, 819200
    s_mov_b32 s39, 0x00020000
    s_mov_b32 s42, 6291456
    s_mov_b32 s43, 0x00020000
    s_mov_b32 s58, 3072
    s_mov_b32 s59, 0x00020000
    s_mov_b32 s46, 6291456
    s_mov_b32 s47, 0x00020000
    s_mov_b32 s62, 4096
    s_mov_b32 s63, 0x00020000
    s_mov_b32 s54, 2621440
    s_mov_b32 s55, 0x00020000
    s_mov_b32 s66, 256
    s_mov_b32 s67, 0x00020000
    s_mov_b32 s50, 16777216
    s_mov_b32 s51, 0x00020000
    s_lshr_b32 s86, s76, 6
    s_lshr_b32 s87, s76, 1
    s_xor_b32 s88, s87, s86
    s_and_b32 s88, s88, 1
    s_mul_i32 s88, s88, 3
    s_lshr_b32 s86, s86, 1
    s_lshl_b32 s86, s86, 3
    s_lshr_b32 s89, s76, 3
    s_and_b32 s89, s89, 7
    s_add_u32 s86, s86, s89
    s_cmp_lt_u32 s86, 15
    s_cselect_b32 s78, 1, 0
    s_cselect_b32 s86, s86, 0
    s_mul_i32 s89, s86, 52
    s_lshr_b32 s89, s89, 8
    s_mul_i32 s90, s89, 5
    s_sub_u32 s90, s86, s90
    s_and_b32 s91, s76, 1
    s_mul_i32 s72, s91, 5
    s_add_u32 s72, s72, s90
    s_and_b32 s87, s87, 3
    s_mul_i32 s73, s87, 6
    s_add_u32 s73, s73, s88
    s_add_u32 s73, s73, s89
    s_mov_b32 s18, 1
    s_mov_b32 s19, s76
    s_lshr_b32 s86, s76, 3
    s_and_b32 s87, s86, 7
    s_lshr_b32 s88, s86, 3
    s_mul_i32 s89, s88, 3
    s_add_u32 s12, s87, s89
    s_mul_i32 s14, s87, 5
    s_add_u32 s14, s14, s89
    s_lshl_b32 s15, s88, 1
    s_add_u32 s15, s15, s87
    s_mul_i32 s13, s73, 3
    s_mul_i32 s89, s72, 5
    s_add_u32 s13, s13, s89
    s_and_b32 s13, s13, 7
    s_cmp_ge_u32 s12, 10
    s_cselect_b32 s91, 10, 0
    s_sub_u32 s12, s12, s91
    s_cmp_ge_u32 s14, 12
    s_cselect_b32 s91, 12, 0
    s_sub_u32 s14, s14, s91
    s_cmp_ge_u32 s14, 12
    s_cselect_b32 s91, 12, 0
    s_sub_u32 s14, s14, s91
    s_cmp_ge_u32 s14, 12
    s_cselect_b32 s91, 12, 0
    s_sub_u32 s14, s14, s91
    s_cmp_ge_u32 s15, 5
    s_cselect_b32 s91, 5, 0
    s_sub_u32 s15, s15, s91
    s_cmp_ge_u32 s15, 5
    s_cselect_b32 s91, 5, 0
    s_sub_u32 s15, s15, s91
    s_mov_b32 s12, 0
    s_mov_b32 s15, 0
    s_cmp_lt_u32 s68, 4
    s_cbranch_scc1 parallel_sum__sliding_block__mixer_token_mlp__prompt_kernel_compute
    v_lshrrev_b32 v20, 3, v0
    v_and_b32 v21, 7, v0
    v_lshrrev_b32 v22, 1, v20
    s_and_b32 s86, s69, 1
    s_lshl_b32 s86, s86, 2
    v_or_b32 v23, s86, v22
    v_xor_b32 v23, v23, v21
    v_lshlrev_b32 v23, 4, v23
    v_mul_u32_u24 v2, 1280, v20
    v_add_u32 v2, v2, v23
    v_lshlrev_b32 v6, 4, v0
    v_lshrrev_b32 v20, 4, v0
    v_and_b32 v21, 15, v0
    v_lshlrev_b32 v22, 2, v20
    v_xor_b32 v22, v22, v21
    v_min_u32 v22, 14, v22
    v_mul_u32_u24 v23, 52, v22
    v_lshrrev_b32 v23, 8, v23
    v_mul_u32_u24 v3, 5, v23
    v_sub_u32 v3, v22, v3
    v_lshlrev_b32 v3, 4, v3
    v_mul_u32_u24 v23, 1280, v23
    v_add_u32 v3, v3, v23
    v_mul_u32_u24 v23, 3840, v20
    v_add_u32 v3, v3, v23
    s_mov_b32 s80, 0
    s_lshl_b32 s82, s70, 7
    s_lshl_b32 s86, s69, 3
    s_add_u32 s82, s82, s86
    s_mul_i32 s82, s82, 1280
    s_mul_i32 s83, s69, 15360
    s_mul_i32 s86, s71, 80
    s_add_u32 s83, s83, s86
    s_mov_b32 s16, s82
    s_mov_b32 s17, s83
    s_mov_b32 s11, 0
    s_lshr_b32 s86, s76, 3
    s_lshr_b32 s87, s86, 3
    s_add_u32 s86, s86, s87
    s_and_b32 s12, s86, 3
    s_waitcnt lgkmcnt(0)
    s_and_b32 s87, s11, 3
    s_cmp_eq_u32 s87, s12
    s_cselect_b32 s88, 1, 0
    s_cmp_eq_u32 s11, 9
    s_cselect_b32 s88, 0, s88
    s_sub_u32 s87, s11, 1
    s_and_b32 s87, s87, 3
    s_cmp_eq_u32 s87, s12
    s_cselect_b32 s89, 1, 0
    s_cmp_eq_u32 s11, 0
    s_cselect_b32 s89, 0, s89
    s_add_u32 s88, s88, s11
    s_sub_u32 s88, s88, s89
    s_add_u32 s11, s11, 1
    s_mul_i32 s87, s88, 128
    s_add_u32 s82, s16, s87
    s_mul_i32 s87, s88, 245760
    s_add_u32 s83, s17, s87
    s_lshl_b32 s84, s69, 10
    s_add_u32 s84, s84, s80
    s_add_u32 m0, s84, 0
    s_add_u32 s86, s82, 0
    buffer_load_dwordx4 v2, s[28:31], s86 offen lds
    s_add_u32 m0, s84, 16384
    s_add_u32 s86, s83, 0
    buffer_load_dwordx4 v3, s[32:35], s86 offen lds
    s_add_u32 m0, s84, 4096
    s_add_u32 s86, s82, 40960
    buffer_load_dwordx4 v2, s[28:31], s86 offen lds
    s_add_u32 m0, s84, 20480
    s_add_u32 s86, s83, 61440
    buffer_load_dwordx4 v3, s[32:35], s86 offen lds
    s_add_u32 m0, s84, 8192
    s_add_u32 s86, s82, 81920
    buffer_load_dwordx4 v2, s[28:31], s86 offen lds
    s_add_u32 m0, s84, 24576
    s_add_u32 s86, s83, 122880
    buffer_load_dwordx4 v3, s[32:35], s86 offen lds
    s_add_u32 m0, s84, 12288
    s_add_u32 s86, s82, 122880
    buffer_load_dwordx4 v2, s[28:31], s86 offen lds
    s_add_u32 m0, s84, 28672
    s_add_u32 s86, s83, 184320
    buffer_load_dwordx4 v3, s[32:35], s86 offen lds
    s_add_u32 s82, s82, 128
    s_add_u32 s83, s83, 245760
    s_add_u32 s80, s80, 36864
    s_cmp_eq_u32 s80, 147456
    s_cselect_b32 s80, 0, s80
    s_load_dword s77, s[48:49], 0
    v_lshrrev_b32 v20, 3, v0
    v_and_b32 v21, 7, v0
    v_lshrrev_b32 v22, 1, v20
    s_and_b32 s86, s69, 1
    s_lshl_b32 s86, s86, 2
    v_or_b32 v23, s86, v22
    v_xor_b32 v23, v23, v21
    v_lshlrev_b32 v23, 4, v23
    v_mul_u32_u24 v2, 1280, v20
    v_add_u32 v2, v2, v23
    v_and_b32 v23, 1, v22
    v_lshlrev_b32 v23, 2, v23
    v_xor_b32 v23, v23, v21
    v_lshlrev_b32 v23, 4, v23
    v_mul_u32_u24 v4, 1280, v20
    v_add_u32 v4, v4, v23
    v_mul_u32_u24 v5, 3072, v20
    v_add_u32 v5, v5, v23
    v_and_b32 v23, 3, v22
    v_lshlrev_b32 v23, 1, v23
    v_xor_b32 v23, v23, v21
    v_lshlrev_b32 v23, 4, v23
    v_lshlrev_b32 v7, 12, v20
    v_add_u32 v7, v7, v23
    v_lshlrev_b32 v6, 4, v0
    v_lshrrev_b32 v20, 4, v0
    v_and_b32 v21, 15, v0
    v_lshlrev_b32 v22, 2, v20
    v_xor_b32 v22, v22, v21
    v_min_u32 v22, 14, v22
    v_mul_u32_u24 v23, 52, v22
    v_lshrrev_b32 v23, 8, v23
    v_mul_u32_u24 v3, 5, v23
    v_sub_u32 v3, v22, v3
    v_lshlrev_b32 v3, 4, v3
    v_mul_u32_u24 v23, 1280, v23
    v_add_u32 v3, v3, v23
    v_mul_u32_u24 v23, 3840, v20
    v_add_u32 v3, v3, v23
    s_lshl_b32 s86, s69, 2
    v_add_u32 v22, s86, v20
    v_xor_b32 v22, v22, v21
    v_lshlrev_b32 v22, 4, v22
    v_mul_u32_u24 v8, 1280, v20
    v_add_u32 v8, v8, v22
    v_add_u32 v20, 0, v0
    v_mul_u32_u24 v21, 6554, v20
    v_lshrrev_b32 v21, 16, v21
    v_mul_u32_u24 v22, 10, v21
    v_sub_u32 v22, v20, v22
    v_lshlrev_b32 v22, 4, v22
    v_mul_u32_u24 v21, 1280, v21
    v_add_u32 v9, v21, v22
    v_add_u32 v20, 64, v0
    v_mul_u32_u24 v21, 6554, v20
    v_lshrrev_b32 v21, 16, v21
    v_mul_u32_u24 v22, 10, v21
    v_sub_u32 v22, v20, v22
    v_lshlrev_b32 v22, 4, v22
    v_mul_u32_u24 v21, 1280, v21
    v_add_u32 v10, v21, v22
    v_add_u32 v20, 128, v0
    v_mul_u32_u24 v21, 6554, v20
    v_lshrrev_b32 v21, 16, v21
    v_mul_u32_u24 v22, 10, v21
    v_sub_u32 v22, v20, v22
    v_lshlrev_b32 v22, 4, v22
    v_mul_u32_u24 v21, 1280, v21
    v_add_u32 v11, v21, v22
    v_add_u32 v20, 192, v0
    v_mul_u32_u24 v21, 6554, v20
    v_lshrrev_b32 v21, 16, v21
    v_mul_u32_u24 v22, 10, v21
    v_sub_u32 v22, v20, v22
    v_lshlrev_b32 v22, 4, v22
    v_mul_u32_u24 v21, 1280, v21
    v_add_u32 v12, v21, v22
    v_add_u32 v20, 256, v0
    v_mul_u32_u24 v21, 6554, v20
    v_lshrrev_b32 v21, 16, v21
    v_mul_u32_u24 v22, 10, v21
    v_sub_u32 v22, v20, v22
    v_lshlrev_b32 v22, 4, v22
    v_mul_u32_u24 v21, 1280, v21
    v_add_u32 v13, v21, v22
    v_lshrrev_b32 v20, 4, v0
    v_mov_b32 v21, s70
    v_cmp_eq_u32 vcc, 3, v20
    s_nop 1
    v_cndmask_b32 v20, v20, v21, vcc
    v_lshlrev_b32 v20, 6, v20
    v_and_b32 v21, 15, v0
    v_lshl_add_u32 v20, v21, 2, v20
    v_add_u32 v14, 4096, v20
    v_and_b32 v20, 63, v0
    v_lshlrev_b32 v20, 4, v20
    v_add_u32 v18, 4096, v20
    v_min_u32 v20, 2, v0
    v_sub_u32 v20, s70, v20
    v_max_i32 v20, 0, v20
    s_lshl_b32 s86, s71, 4
    v_add_u32 v20, s86, v20
    v_lshlrev_b32 v20, 2, v20
    v_add_u32 v15, 5120, v20
    v_and_b32 v20, 15, v0
    s_lshr_b32 s86, s74, 1
    s_lshl_b32 s86, s86, 4
    v_add_u32 v20, s86, v20
    v_lshlrev_b32 v20, 2, v20
    v_add_u32 v17, 6144, v20
    v_min_u32 v20, 47, v0
    v_mul_u32_u24 v21, 2731, v20
    v_lshrrev_b32 v21, 16, v21
    v_mul_u32_u24 v22, 24, v21
    v_sub_u32 v22, v20, v22
    s_mul_i32 s86, s75, 80
    s_lshr_b32 s86, s86, 6
    v_add_u32 v21, s86, v21
    v_lshlrev_b32 v21, 2, v21
    v_lshl_add_u32 v21, v22, 6, v21
    s_and_b32 s86, s76, 7
    s_mul_i32 s86, s86, 1536
    s_add_u32 s86, s86, 32768
    v_add_u32 v16, s86, v21
    v_and_b32 v21, 15, v0
    v_lshrrev_b32 v22, 2, v21
    v_mul_u32_u24 v22, 6, v22
    v_and_b32 v23, 1, v21
    v_add_u32 v22, v22, v23
    v_lshlrev_b32 v22, 6, v22
    v_bfe_u32 v23, v21, 1, 1
    s_mul_i32 s87, s75, 80
    s_lshr_b32 s87, s87, 6
    v_add_u32 v23, s87, v23
    v_lshl_add_u32 v22, v23, 2, v22
    v_add_u32 v14, s86, v22
    s_cmp_eq_u32 s69, 0
    s_cselect_b32 s86, 0, 2146435072
    v_add_u32 v14, s86, v14
    v_add_u32 v18, s86, v18
    v_add_u32 v15, s86, v15
    v_add_u32 v17, s86, v17
    v_add_u32 v16, s86, v16
    s_waitcnt lgkmcnt(0)
    s_mul_i32 s77, s77, 1664525
    s_add_u32 s77, s77, 1013904223
    s_and_b32 s87, s11, 3
    s_cmp_eq_u32 s87, s12
    s_cselect_b32 s88, 1, 0
    s_cmp_eq_u32 s11, 9
    s_cselect_b32 s88, 0, s88
    s_sub_u32 s87, s11, 1
    s_and_b32 s87, s87, 3
    s_cmp_eq_u32 s87, s12
    s_cselect_b32 s89, 1, 0
    s_cmp_eq_u32 s11, 0
    s_cselect_b32 s89, 0, s89
    s_add_u32 s88, s88, s11
    s_sub_u32 s88, s88, s89
    s_add_u32 s11, s11, 1
    s_mul_i32 s87, s88, 128
    s_add_u32 s82, s16, s87
    s_mul_i32 s87, s88, 245760
    s_add_u32 s83, s17, s87
    s_lshl_b32 s84, s69, 10
    s_add_u32 s84, s84, s80
    s_add_u32 m0, s84, 0
    s_add_u32 s86, s82, 0
    buffer_load_dwordx4 v2, s[28:31], s86 offen lds
    s_add_u32 m0, s84, 16384
    s_add_u32 s86, s83, 0
    buffer_load_dwordx4 v3, s[32:35], s86 offen lds
    s_add_u32 m0, s84, 4096
    s_add_u32 s86, s82, 40960
    buffer_load_dwordx4 v2, s[28:31], s86 offen lds
    s_add_u32 m0, s84, 20480
    s_add_u32 s86, s83, 61440
    buffer_load_dwordx4 v3, s[32:35], s86 offen lds
    s_add_u32 m0, s84, 8192
    s_add_u32 s86, s82, 81920
    buffer_load_dwordx4 v2, s[28:31], s86 offen lds
    s_add_u32 m0, s84, 24576
    s_add_u32 s86, s83, 122880
    buffer_load_dwordx4 v3, s[32:35], s86 offen lds
    s_add_u32 m0, s84, 12288
    s_add_u32 s86, s82, 122880
    buffer_load_dwordx4 v2, s[28:31], s86 offen lds
    s_add_u32 m0, s84, 28672
    s_add_u32 s86, s83, 184320
    buffer_load_dwordx4 v3, s[32:35], s86 offen lds
    s_add_u32 s82, s82, 128
    s_add_u32 s83, s83, 245760
    s_add_u32 s80, s80, 36864
    s_cmp_eq_u32 s80, 147456
    s_cselect_b32 s80, 0, s80
    s_and_b32 s87, s11, 3
    s_cmp_eq_u32 s87, s12
    s_cselect_b32 s88, 1, 0
    s_cmp_eq_u32 s11, 9
    s_cselect_b32 s88, 0, s88
    s_sub_u32 s87, s11, 1
    s_and_b32 s87, s87, 3
    s_cmp_eq_u32 s87, s12
    s_cselect_b32 s89, 1, 0
    s_cmp_eq_u32 s11, 0
    s_cselect_b32 s89, 0, s89
    s_add_u32 s88, s88, s11
    s_sub_u32 s88, s88, s89
    s_add_u32 s11, s11, 1
    s_mul_i32 s87, s88, 128
    s_add_u32 s82, s16, s87
    s_mul_i32 s87, s88, 245760
    s_add_u32 s83, s17, s87
    s_lshl_b32 s84, s69, 10
    s_add_u32 s84, s84, s80
    s_add_u32 m0, s84, 0
    s_add_u32 s86, s82, 0
    buffer_load_dwordx4 v2, s[28:31], s86 offen lds
    s_add_u32 m0, s84, 16384
    s_add_u32 s86, s83, 0
    buffer_load_dwordx4 v3, s[32:35], s86 offen lds
    s_add_u32 m0, s84, 4096
    s_add_u32 s86, s82, 40960
    buffer_load_dwordx4 v2, s[28:31], s86 offen lds
    s_add_u32 m0, s84, 20480
    s_add_u32 s86, s83, 61440
    buffer_load_dwordx4 v3, s[32:35], s86 offen lds
    s_add_u32 m0, s84, 8192
    s_add_u32 s86, s82, 81920
    buffer_load_dwordx4 v2, s[28:31], s86 offen lds
    s_add_u32 m0, s84, 24576
    s_add_u32 s86, s83, 122880
    buffer_load_dwordx4 v3, s[32:35], s86 offen lds
    s_add_u32 m0, s84, 12288
    s_add_u32 s86, s82, 122880
    buffer_load_dwordx4 v2, s[28:31], s86 offen lds
    s_add_u32 m0, s84, 28672
    s_add_u32 s86, s83, 184320
    buffer_load_dwordx4 v3, s[32:35], s86 offen lds
    s_add_u32 s82, s82, 128
    s_add_u32 s83, s83, 245760
    s_add_u32 s80, s80, 36864
    s_cmp_eq_u32 s80, 147456
    s_cselect_b32 s80, 0, s80
    s_mul_i32 s86, s76, 12288
    s_mul_i32 s87, s69, 3072
    s_add_u32 s86, s86, s87
    s_add_u32 s86, s86, 0
    buffer_load_dwordx4 v[96:99], v6, s[40:43], s86 offen offset:0
    buffer_load_dwordx4 v[96:99], v6, s[40:43], s86 offen offset:1024
    buffer_load_dwordx4 v[96:99], v6, s[40:43], s86 offen offset:2048
    s_waitcnt vmcnt(19)
    s_barrier
    s_and_b32 s87, s11, 3
    s_cmp_eq_u32 s87, s12
    s_cselect_b32 s88, 1, 0
    s_cmp_eq_u32 s11, 9
    s_cselect_b32 s88, 0, s88
    s_sub_u32 s87, s11, 1
    s_and_b32 s87, s87, 3
    s_cmp_eq_u32 s87, s12
    s_cselect_b32 s89, 1, 0
    s_cmp_eq_u32 s11, 0
    s_cselect_b32 s89, 0, s89
    s_add_u32 s88, s88, s11
    s_sub_u32 s88, s88, s89
    s_add_u32 s11, s11, 1
    s_mul_i32 s87, s88, 128
    s_add_u32 s82, s16, s87
    s_mul_i32 s87, s88, 245760
    s_add_u32 s83, s17, s87
    s_lshl_b32 s84, s69, 10
    s_add_u32 s84, s84, s80
    s_add_u32 m0, s84, 0
    s_add_u32 s86, s82, 0
    buffer_load_dwordx4 v2, s[28:31], s86 offen lds
    s_add_u32 m0, s84, 16384
    s_add_u32 s86, s83, 0
    buffer_load_dwordx4 v3, s[32:35], s86 offen lds
    s_add_u32 m0, s84, 4096
    s_add_u32 s86, s82, 40960
    buffer_load_dwordx4 v2, s[28:31], s86 offen lds
    s_add_u32 m0, s84, 20480
    s_add_u32 s86, s83, 61440
    buffer_load_dwordx4 v3, s[32:35], s86 offen lds
    s_add_u32 m0, s84, 8192
    s_add_u32 s86, s82, 81920
    buffer_load_dwordx4 v2, s[28:31], s86 offen lds
    s_add_u32 m0, s84, 24576
    s_add_u32 s86, s83, 122880
    buffer_load_dwordx4 v3, s[32:35], s86 offen lds
    s_add_u32 m0, s84, 12288
    s_add_u32 s86, s82, 122880
    buffer_load_dwordx4 v2, s[28:31], s86 offen lds
    s_add_u32 m0, s84, 28672
    s_add_u32 s86, s83, 184320
    buffer_load_dwordx4 v3, s[32:35], s86 offen lds
    s_add_u32 s82, s82, 128
    s_add_u32 s83, s83, 245760
    s_add_u32 s80, s80, 36864
    s_cmp_eq_u32 s80, 147456
    s_cselect_b32 s80, 0, s80
    s_waitcnt vmcnt(19)
    s_barrier
    s_and_b32 s87, s11, 3
    s_cmp_eq_u32 s87, s12
    s_cselect_b32 s88, 1, 0
    s_cmp_eq_u32 s11, 9
    s_cselect_b32 s88, 0, s88
    s_sub_u32 s87, s11, 1
    s_and_b32 s87, s87, 3
    s_cmp_eq_u32 s87, s12
    s_cselect_b32 s89, 1, 0
    s_cmp_eq_u32 s11, 0
    s_cselect_b32 s89, 0, s89
    s_add_u32 s88, s88, s11
    s_sub_u32 s88, s88, s89
    s_add_u32 s11, s11, 1
    s_mul_i32 s87, s88, 128
    s_add_u32 s82, s16, s87
    s_mul_i32 s87, s88, 245760
    s_add_u32 s83, s17, s87
    s_lshl_b32 s84, s69, 10
    s_add_u32 s84, s84, s80
    s_add_u32 m0, s84, 0
    s_add_u32 s86, s82, 0
    buffer_load_dwordx4 v2, s[28:31], s86 offen lds
    s_add_u32 m0, s84, 16384
    s_add_u32 s86, s83, 0
    buffer_load_dwordx4 v3, s[32:35], s86 offen lds
    s_add_u32 m0, s84, 4096
    s_add_u32 s86, s82, 40960
    buffer_load_dwordx4 v2, s[28:31], s86 offen lds
    s_add_u32 m0, s84, 20480
    s_add_u32 s86, s83, 61440
    buffer_load_dwordx4 v3, s[32:35], s86 offen lds
    s_add_u32 m0, s84, 8192
    s_add_u32 s86, s82, 81920
    buffer_load_dwordx4 v2, s[28:31], s86 offen lds
    s_add_u32 m0, s84, 24576
    s_add_u32 s86, s83, 122880
    buffer_load_dwordx4 v3, s[32:35], s86 offen lds
    s_add_u32 m0, s84, 12288
    s_add_u32 s86, s82, 122880
    buffer_load_dwordx4 v2, s[28:31], s86 offen lds
    s_add_u32 m0, s84, 28672
    s_add_u32 s86, s83, 184320
    buffer_load_dwordx4 v3, s[32:35], s86 offen lds
    s_add_u32 s82, s82, 128
    s_add_u32 s83, s83, 245760
    s_add_u32 s80, s80, 36864
    s_cmp_eq_u32 s80, 147456
    s_cselect_b32 s80, 0, s80
    s_waitcnt vmcnt(19)
    s_barrier
    s_cmp_lg_u32 s69, 0
    s_cbranch_scc1 Lw0_1001
    s_cmp_eq_u32 s18, 0
    s_cbranch_scc1 Llnoff_1002
    s_lshl_b32 s90, s19, 2
    s_add_u32 s90, s90, 4096
    s_atomic_swap s77, s[48:49], s90
Llnoff_1002:
    s_mov_b32 s4, 1
    s_atomic_add s4, s[64:65], 0x0 glc
Lw0_1001:
    s_and_b32 s87, s11, 3
    s_cmp_eq_u32 s87, s12
    s_cselect_b32 s88, 1, 0
    s_cmp_eq_u32 s11, 9
    s_cselect_b32 s88, 0, s88
    s_sub_u32 s87, s11, 1
    s_and_b32 s87, s87, 3
    s_cmp_eq_u32 s87, s12
    s_cselect_b32 s89, 1, 0
    s_cmp_eq_u32 s11, 0
    s_cselect_b32 s89, 0, s89
    s_add_u32 s88, s88, s11
    s_sub_u32 s88, s88, s89
    s_add_u32 s11, s11, 1
    s_mul_i32 s87, s88, 128
    s_add_u32 s82, s16, s87
    s_mul_i32 s87, s88, 245760
    s_add_u32 s83, s17, s87
    s_lshl_b32 s84, s69, 10
    s_add_u32 s84, s84, s80
    s_add_u32 m0, s84, 0
    s_add_u32 s86, s82, 0
    buffer_load_dwordx4 v2, s[28:31], s86 offen lds
    s_add_u32 m0, s84, 16384
    s_add_u32 s86, s83, 0
    buffer_load_dwordx4 v3, s[32:35], s86 offen lds
    s_add_u32 m0, s84, 4096
    s_add_u32 s86, s82, 40960
    buffer_load_dwordx4 v2, s[28:31], s86 offen lds
    s_add_u32 m0, s84, 20480
    s_add_u32 s86, s83, 61440
    buffer_load_dwordx4 v3, s[32:35], s86 offen lds
    s_add_u32 m0, s84, 8192
    s_add_u32 s86, s82, 81920
    buffer_load_dwordx4 v2, s[28:31], s86 offen lds
    s_add_u32 m0, s84, 24576
    s_add_u32 s86, s83, 122880
    buffer_load_dwordx4 v3, s[32:35], s86 offen lds
    s_add_u32 m0, s84, 12288
    s_add_u32 s86, s82, 122880
    buffer_load_dwordx4 v2, s[28:31], s86 offen lds
    s_add_u32 m0, s84, 28672
    s_add_u32 s86, s83, 184320
    buffer_load_dwordx4 v3, s[32:35], s86 offen lds
    s_add_u32 s82, s82, 128
    s_add_u32 s83, s83, 245760
    s_add_u32 s80, s80, 36864
    s_cmp_eq_u32 s80, 147456
    s_cselect_b32 s80, 0, s80
    s_waitcnt vmcnt(16)
    s_barrier
    s_and_b32 s87, s11, 3
    s_cmp_eq_u32 s87, s12
    s_cselect_b32 s88, 1, 0
    s_cmp_eq_u32 s11, 9
    s_cselect_b32 s88, 0, s88
    s_sub_u32 s87, s11, 1
    s_and_b32 s87, s87, 3
    s_cmp_eq_u32 s87, s12
    s_cselect_b32 s89, 1, 0
    s_cmp_eq_u32 s11, 0
    s_cselect_b32 s89, 0, s89
    s_add_u32 s88, s88, s11
    s_sub_u32 s88, s88, s89
    s_add_u32 s11, s11, 1
    s_mul_i32 s87, s88, 128
    s_add_u32 s82, s16, s87
    s_mul_i32 s87, s88, 245760
    s_add_u32 s83, s17, s87
    s_lshl_b32 s84, s69, 10
    s_add_u32 s84, s84, s80
    s_add_u32 m0, s84, 0
    s_add_u32 s86, s82, 0
    buffer_load_dwordx4 v2, s[28:31], s86 offen lds
    s_add_u32 m0, s84, 16384
    s_add_u32 s86, s83, 0
    buffer_load_dwordx4 v3, s[32:35], s86 offen lds
    s_add_u32 m0, s84, 4096
    s_add_u32 s86, s82, 40960
    buffer_load_dwordx4 v2, s[28:31], s86 offen lds
    s_add_u32 m0, s84, 20480
    s_add_u32 s86, s83, 61440
    buffer_load_dwordx4 v3, s[32:35], s86 offen lds
    s_add_u32 m0, s84, 8192
    s_add_u32 s86, s82, 81920
    buffer_load_dwordx4 v2, s[28:31], s86 offen lds
    s_add_u32 m0, s84, 24576
    s_add_u32 s86, s83, 122880
    buffer_load_dwordx4 v3, s[32:35], s86 offen lds
    s_add_u32 m0, s84, 12288
    s_add_u32 s86, s82, 122880
    buffer_load_dwordx4 v2, s[28:31], s86 offen lds
    s_add_u32 m0, s84, 28672
    s_add_u32 s86, s83, 184320
    buffer_load_dwordx4 v3, s[32:35], s86 offen lds
    s_add_u32 s82, s82, 128
    s_add_u32 s83, s83, 245760
    s_add_u32 s80, s80, 36864
    s_cmp_eq_u32 s80, 147456
    s_cselect_b32 s80, 0, s80
    s_waitcnt vmcnt(16)
    s_barrier
    s_and_b32 s87, s11, 3
    s_cmp_eq_u32 s87, s12
    s_cselect_b32 s88, 1, 0
    s_cmp_eq_u32 s11, 9
    s_cselect_b32 s88, 0, s88
    s_sub_u32 s87, s11, 1
    s_and_b32 s87, s87, 3
    s_cmp_eq_u32 s87, s12
    s_cselect_b32 s89, 1, 0
    s_cmp_eq_u32 s11, 0
    s_cselect_b32 s89, 0, s89
    s_add_u32 s88, s88, s11
    s_sub_u32 s88, s88, s89
    s_add_u32 s11, s11, 1
    s_mul_i32 s87, s88, 128
    s_add_u32 s82, s16, s87
    s_mul_i32 s87, s88, 245760
    s_add_u32 s83, s17, s87
    s_lshl_b32 s84, s69, 10
    s_add_u32 s84, s84, s80
    s_add_u32 m0, s84, 0
    s_add_u32 s86, s82, 0
    buffer_load_dwordx4 v2, s[28:31], s86 offen lds
    s_add_u32 m0, s84, 16384
    s_add_u32 s86, s83, 0
    buffer_load_dwordx4 v3, s[32:35], s86 offen lds
    s_add_u32 m0, s84, 4096
    s_add_u32 s86, s82, 40960
    buffer_load_dwordx4 v2, s[28:31], s86 offen lds
    s_add_u32 m0, s84, 20480
    s_add_u32 s86, s83, 61440
    buffer_load_dwordx4 v3, s[32:35], s86 offen lds
    s_add_u32 m0, s84, 8192
    s_add_u32 s86, s82, 81920
    buffer_load_dwordx4 v2, s[28:31], s86 offen lds
    s_add_u32 m0, s84, 24576
    s_add_u32 s86, s83, 122880
    buffer_load_dwordx4 v3, s[32:35], s86 offen lds
    s_add_u32 m0, s84, 12288
    s_add_u32 s86, s82, 122880
    buffer_load_dwordx4 v2, s[28:31], s86 offen lds
    s_add_u32 m0, s84, 28672
    s_add_u32 s86, s83, 184320
    buffer_load_dwordx4 v3, s[32:35], s86 offen lds
    s_add_u32 s82, s82, 128
    s_add_u32 s83, s83, 245760
    s_add_u32 s80, s80, 36864
    s_cmp_eq_u32 s80, 147456
    s_cselect_b32 s80, 0, s80
    s_waitcnt vmcnt(16)
    s_barrier
    s_and_b32 s87, s11, 3
    s_cmp_eq_u32 s87, s12
    s_cselect_b32 s88, 1, 0
    s_cmp_eq_u32 s11, 9
    s_cselect_b32 s88, 0, s88
    s_sub_u32 s87, s11, 1
    s_and_b32 s87, s87, 3
    s_cmp_eq_u32 s87, s12
    s_cselect_b32 s89, 1, 0
    s_cmp_eq_u32 s11, 0
    s_cselect_b32 s89, 0, s89
    s_add_u32 s88, s88, s11
    s_sub_u32 s88, s88, s89
    s_add_u32 s11, s11, 1
    s_mul_i32 s87, s88, 128
    s_add_u32 s82, s16, s87
    s_mul_i32 s87, s88, 245760
    s_add_u32 s83, s17, s87
    s_lshl_b32 s84, s69, 10
    s_add_u32 s84, s84, s80
    s_add_u32 m0, s84, 0
    s_add_u32 s86, s82, 0
    buffer_load_dwordx4 v2, s[28:31], s86 offen lds
    s_add_u32 m0, s84, 16384
    s_add_u32 s86, s83, 0
    buffer_load_dwordx4 v3, s[32:35], s86 offen lds
    s_add_u32 m0, s84, 4096
    s_add_u32 s86, s82, 40960
    buffer_load_dwordx4 v2, s[28:31], s86 offen lds
    s_add_u32 m0, s84, 20480
    s_add_u32 s86, s83, 61440
    buffer_load_dwordx4 v3, s[32:35], s86 offen lds
    s_add_u32 m0, s84, 8192
    s_add_u32 s86, s82, 81920
    buffer_load_dwordx4 v2, s[28:31], s86 offen lds
    s_add_u32 m0, s84, 24576
    s_add_u32 s86, s83, 122880
    buffer_load_dwordx4 v3, s[32:35], s86 offen lds
    s_add_u32 m0, s84, 12288
    s_add_u32 s86, s82, 122880
    buffer_load_dwordx4 v2, s[28:31], s86 offen lds
    s_add_u32 m0, s84, 28672
    s_add_u32 s86, s83, 184320
    buffer_load_dwordx4 v3, s[32:35], s86 offen lds
    s_add_u32 s82, s82, 128
    s_add_u32 s83, s83, 245760
    s_add_u32 s80, s80, 36864
    s_cmp_eq_u32 s80, 147456
    s_cselect_b32 s80, 0, s80
    s_waitcnt vmcnt(16)
    s_barrier
    buffer_load_dwordx4 v[24:27], v18, s[48:51], 0 offen sc1
    s_and_b32 s87, s11, 3
    s_cmp_eq_u32 s87, s12
    s_cselect_b32 s88, 1, 0
    s_cmp_eq_u32 s11, 9
    s_cselect_b32 s88, 0, s88
    s_sub_u32 s87, s11, 1
    s_and_b32 s87, s87, 3
    s_cmp_eq_u32 s87, s12
    s_cselect_b32 s89, 1, 0
    s_cmp_eq_u32 s11, 0
    s_cselect_b32 s89, 0, s89
    s_add_u32 s88, s88, s11
    s_sub_u32 s88, s88, s89
    s_add_u32 s11, s11, 1
    s_mul_i32 s87, s88, 128
    s_add_u32 s82, s16, s87
    s_mul_i32 s87, s88, 245760
    s_add_u32 s83, s17, s87
    s_lshl_b32 s84, s69, 10
    s_add_u32 s84, s84, s80
    s_add_u32 m0, s84, 0
    s_add_u32 s86, s82, 0
    buffer_load_dwordx4 v2, s[28:31], s86 offen lds
    s_add_u32 m0, s84, 16384
    s_add_u32 s86, s83, 0
    buffer_load_dwordx4 v3, s[32:35], s86 offen lds
    s_add_u32 m0, s84, 4096
    s_add_u32 s86, s82, 40960
    buffer_load_dwordx4 v2, s[28:31], s86 offen lds
    s_add_u32 m0, s84, 20480
    s_add_u32 s86, s83, 61440
    buffer_load_dwordx4 v3, s[32:35], s86 offen lds
    s_add_u32 m0, s84, 8192
    s_add_u32 s86, s82, 81920
    buffer_load_dwordx4 v2, s[28:31], s86 offen lds
    s_add_u32 m0, s84, 24576
    s_add_u32 s86, s83, 122880
    buffer_load_dwordx4 v3, s[32:35], s86 offen lds
    s_add_u32 m0, s84, 12288
    s_add_u32 s86, s82, 122880
    buffer_load_dwordx4 v2, s[28:31], s86 offen lds
    s_add_u32 m0, s84, 28672
    s_add_u32 s86, s83, 184320
    buffer_load_dwordx4 v3, s[32:35], s86 offen lds
    s_add_u32 s82, s82, 128
    s_add_u32 s83, s83, 245760
    s_add_u32 s80, s80, 36864
    s_cmp_eq_u32 s80, 147456
    s_cselect_b32 s80, 0, s80
    s_waitcnt vmcnt(17)
    s_barrier
    s_waitcnt vmcnt(8)
    s_cmp_lg_u32 s69, 0
    s_cbranch_scc1 Lw0_1003
    v_cmp_eq_u32 s[86:87], s77, v24
    v_cmp_eq_u32 s[88:89], s77, v25
    s_nop 3
    s_and_b64 s[86:87], s[86:87], s[88:89]
    v_cmp_eq_u32 s[88:89], s77, v26
    s_nop 3
    s_and_b64 s[86:87], s[86:87], s[88:89]
    v_cmp_eq_u32 s[88:89], s77, v27
    s_nop 3
    s_and_b64 s[86:87], s[86:87], s[88:89]
    s_cmp_eq_u64 s[86:87], exec
    s_cbranch_scc1 Lpok_1004
    s_mov_b32 s85, 100000
Lspin_1005:
    s_sleep 2
    buffer_load_dwordx4 v[24:27], v18, s[48:51], 0 offen sc1
    s_waitcnt vmcnt(0)
    v_cmp_eq_u32 s[86:87], s77, v24
    v_cmp_eq_u32 s[88:89], s77, v25
    s_nop 3
    s_and_b64 s[86:87], s[86:87], s[88:89]
    v_cmp_eq_u32 s[88:89], s77, v26
    s_nop 3
    s_and_b64 s[86:87], s[86:87], s[88:89]
    v_cmp_eq_u32 s[88:89], s77, v27
    s_nop 3
    s_and_b64 s[86:87], s[86:87], s[88:89]
    s_cmp_eq_u64 s[86:87], exec
    s_cbranch_scc1 Lpok_1004
    s_sub_u32 s85, s85, 1
    s_cmp_lg_u32 s85, 0
    s_cbranch_scc1 Lspin_1005
Lpok_1004:
Lw0_1003:
    s_barrier
    s_mul_i32 s82, s69, 10240
    s_lshl_b32 s86, s72, 7
    s_add_u32 s82, s82, s86
    s_add_u32 s82, s82, 65536
    s_mul_i32 s83, s69, 24576
    s_lshl_b32 s86, s73, 7
    s_add_u32 s83, s83, s86
    s_mov_b32 s9, s13
    s_mov_b32 s11, 0
    s_mul_i32 s86, s13, 163840
    s_add_u32 s82, s82, s86
    s_mul_i32 s86, s13, 393216
    s_add_u32 s83, s83, s86
    s_lshl_b32 s84, s69, 10
    s_add_u32 s84, s84, s80
    s_add_u32 m0, s84, 16384
    s_add_u32 s86, s83, 0
    buffer_load_dwordx4 v5, s[40:43], s86 offen lds
    s_add_u32 m0, s84, 0
    s_add_u32 s86, s82, 0
    buffer_load_dwordx4 v4, s[48:51], s86 offen sc1 lds
    s_add_u32 m0, s84, 20480
    s_add_u32 s86, s83, 98304
    buffer_load_dwordx4 v5, s[40:43], s86 offen lds
    s_add_u32 m0, s84, 4096
    s_add_u32 s86, s82, 40960
    buffer_load_dwordx4 v4, s[48:51], s86 offen sc1 lds
    s_add_u32 m0, s84, 24576
    s_add_u32 s86, s83, 196608
    buffer_load_dwordx4 v5, s[40:43], s86 offen lds
    s_add_u32 m0, s84, 8192
    s_add_u32 s86, s82, 81920
    buffer_load_dwordx4 v4, s[48:51], s86 offen sc1 lds
    s_add_u32 m0, s84, 28672
    s_add_u32 s86, s83, 294912
    buffer_load_dwordx4 v5, s[40:43], s86 offen lds
    s_add_u32 m0, s84, 12288
    s_add_u32 s86, s82, 122880
    buffer_load_dwordx4 v4, s[48:51], s86 offen sc1 lds
    s_add_u32 s82, s82, 163840
    s_add_u32 s83, s83, 393216
    s_add_u32 s80, s80, 36864
    s_cmp_eq_u32 s80, 147456
    s_cselect_b32 s80, 0, s80
    s_add_u32 s9, s9, 1
    s_cmp_eq_u32 s9, 8
    s_cselect_b32 s9, 0, s9
    s_cselect_b32 s87, 1310720, 0
    s_cselect_b32 s88, 3145728, 0
    s_sub_u32 s82, s82, s87
    s_sub_u32 s83, s83, s88
    s_add_u32 s11, s11, 1
    s_cmp_eq_u32 s11, 8
    s_cselect_b32 s87, 1310720, 0
    s_cselect_b32 s88, 3145728, 0
    s_add_u32 s82, s82, s87
    s_add_u32 s83, s83, s88
    s_waitcnt vmcnt(8)
    s_barrier
    s_lshl_b32 s84, s69, 10
    s_add_u32 s84, s84, s80
    s_add_u32 m0, s84, 16384
    s_add_u32 s86, s83, 0
    buffer_load_dwordx4 v5, s[40:43], s86 offen lds
    s_add_u32 m0, s84, 0
    s_add_u32 s86, s82, 0
    buffer_load_dwordx4 v4, s[48:51], s86 offen sc1 lds
    s_add_u32 m0, s84, 20480
    s_add_u32 s86, s83, 98304
    buffer_load_dwordx4 v5, s[40:43], s86 offen lds
    s_add_u32 m0, s84, 4096
    s_add_u32 s86, s82, 40960
    buffer_load_dwordx4 v4, s[48:51], s86 offen sc1 lds
    s_add_u32 m0, s84, 24576
    s_add_u32 s86, s83, 196608
    buffer_load_dwordx4 v5, s[40:43], s86 offen lds
    s_add_u32 m0, s84, 8192
    s_add_u32 s86, s82, 81920
    buffer_load_dwordx4 v4, s[48:51], s86 offen sc1 lds
    s_add_u32 m0, s84, 28672
    s_add_u32 s86, s83, 294912
    buffer_load_dwordx4 v5, s[40:43], s86 offen lds
    s_add_u32 m0, s84, 12288
    s_add_u32 s86, s82, 122880
    buffer_load_dwordx4 v4, s[48:51], s86 offen sc1 lds
    s_add_u32 s82, s82, 163840
    s_add_u32 s83, s83, 393216
    s_add_u32 s80, s80, 36864
    s_cmp_eq_u32 s80, 147456
    s_cselect_b32 s80, 0, s80
    s_add_u32 s9, s9, 1
    s_cmp_eq_u32 s9, 8
    s_cselect_b32 s9, 0, s9
    s_cselect_b32 s87, 1310720, 0
    s_cselect_b32 s88, 3145728, 0
    s_sub_u32 s82, s82, s87
    s_sub_u32 s83, s83, s88
    s_add_u32 s11, s11, 1
    s_cmp_eq_u32 s11, 8
    s_cselect_b32 s87, 1310720, 0
    s_cselect_b32 s88, 3145728, 0
    s_add_u32 s82, s82, s87
    s_add_u32 s83, s83, s88
    s_lshl_b32 s84, s69, 10
    s_add_u32 s84, s84, s80
    s_add_u32 m0, s84, 16384
    s_add_u32 s86, s83, 0
    buffer_load_dwordx4 v5, s[40:43], s86 offen lds
    s_add_u32 m0, s84, 0
    s_add_u32 s86, s82, 0
    buffer_load_dwordx4 v4, s[48:51], s86 offen sc1 lds
    s_add_u32 m0, s84, 20480
    s_add_u32 s86, s83, 98304
    buffer_load_dwordx4 v5, s[40:43], s86 offen lds
    s_add_u32 m0, s84, 4096
    s_add_u32 s86, s82, 40960
    buffer_load_dwordx4 v4, s[48:51], s86 offen sc1 lds
    s_add_u32 m0, s84, 24576
    s_add_u32 s86, s83, 196608
    buffer_load_dwordx4 v5, s[40:43], s86 offen lds
    s_add_u32 m0, s84, 8192
    s_add_u32 s86, s82, 81920
    buffer_load_dwordx4 v4, s[48:51], s86 offen sc1 lds
    s_add_u32 m0, s84, 28672
    s_add_u32 s86, s83, 294912
    buffer_load_dwordx4 v5, s[40:43], s86 offen lds
    s_add_u32 m0, s84, 12288
    s_add_u32 s86, s82, 122880
    buffer_load_dwordx4 v4, s[48:51], s86 offen sc1 lds
    s_add_u32 s82, s82, 163840
    s_add_u32 s83, s83, 393216
    s_add_u32 s80, s80, 36864
    s_cmp_eq_u32 s80, 147456
    s_cselect_b32 s80, 0, s80
    s_add_u32 s9, s9, 1
    s_cmp_eq_u32 s9, 8
    s_cselect_b32 s9, 0, s9
    s_cselect_b32 s87, 1310720, 0
    s_cselect_b32 s88, 3145728, 0
    s_sub_u32 s82, s82, s87
    s_sub_u32 s83, s83, s88
    s_add_u32 s11, s11, 1
    s_cmp_eq_u32 s11, 8
    s_cselect_b32 s87, 1310720, 0
    s_cselect_b32 s88, 3145728, 0
    s_add_u32 s82, s82, s87
    s_add_u32 s83, s83, s88
    s_mul_i32 s86, s76, 12288
    s_mul_i32 s87, s69, 3072
    s_add_u32 s86, s86, s87
    s_add_u32 s86, s86, 3145728
    buffer_load_dwordx4 v[96:99], v6, s[40:43], s86 offen offset:0
    buffer_load_dwordx4 v[96:99], v6, s[40:43], s86 offen offset:1024
    buffer_load_dwordx4 v[96:99], v6, s[40:43], s86 offen offset:2048
    s_barrier
    s_barrier
    v_lshlrev_b32 v28, 4, v0
    s_lshl_b32 s86, s69, 10
    v_add_u32 v28, s86, v28
    v_add_u32 v29, 36864, v28
    s_lshl_b32 s87, s71, 11
    s_lshl_b32 s88, s70, 7
    s_add_u32 s87, s87, s88
    s_mul_i32 s87, s87, 168
    s_add_u32 s87, s87, 5308416
    v_add_u32 v30, s87, v28
    s_cmp_eq_u32 s69, 0
    s_cselect_b32 s88, 0, 2146435072
    v_add_u32 v31, s88, v30
    ds_read_b128 v[32:35], v29 offset:0
    ds_read_b128 v[36:39], v29 offset:4096
    ds_read_b128 v[40:43], v29 offset:8192
    ds_read_b128 v[44:47], v29 offset:12288
    ds_read_b128 v[48:51], v29 offset:16384
    ds_read_b128 v[52:55], v29 offset:20480
    s_waitcnt lgkmcnt(5)
    s_mov_b32 s86, 0
    buffer_store_dwordx4 v[32:35], v30, s[48:51], s86 offen sc1
    s_waitcnt lgkmcnt(4)
    s_mov_b32 s86, 4096
    buffer_store_dwordx4 v[36:39], v30, s[48:51], s86 offen sc1
    s_waitcnt lgkmcnt(3)
    s_mov_b32 s86, 8192
    buffer_store_dwordx4 v[40:43], v30, s[48:51], s86 offen sc1
    s_waitcnt lgkmcnt(2)
    s_mov_b32 s86, 12288
    buffer_store_dwordx4 v[44:47], v30, s[48:51], s86 offen sc1
    s_waitcnt lgkmcnt(1)
    s_mov_b32 s86, 16384
    buffer_store_dwordx4 v[48:51], v30, s[48:51], s86 offen sc1
    s_waitcnt lgkmcnt(0)
    s_mov_b32 s86, 20480
    buffer_store_dwordx4 v[52:55], v31, s[48:51], s86 offen sc1
    s_waitcnt vmcnt(25)
    s_cmp_lg_u32 s69, 0
    s_cbranch_scc1 Lw0_1006
    s_waitcnt lgkmcnt(0)
    s_cmp_lg_u32 s4, 255
    s_cbranch_scc1 Lep_1007
    s_mov_b32 s90, 0
    s_atomic_swap s77, s[48:49], s90
Lep_1007:
Lw0_1006:
    s_barrier
    s_lshl_b32 s84, s69, 10
    s_add_u32 s84, s84, s80
    s_add_u32 m0, s84, 16384
    s_add_u32 s86, s83, 0
    buffer_load_dwordx4 v5, s[40:43], s86 offen lds
    s_add_u32 m0, s84, 0
    s_add_u32 s86, s82, 0
    buffer_load_dwordx4 v4, s[48:51], s86 offen sc1 lds
    s_add_u32 m0, s84, 20480
    s_add_u32 s86, s83, 98304
    buffer_load_dwordx4 v5, s[40:43], s86 offen lds
    s_add_u32 m0, s84, 4096
    s_add_u32 s86, s82, 40960
    buffer_load_dwordx4 v4, s[48:51], s86 offen sc1 lds
    s_add_u32 m0, s84, 24576
    s_add_u32 s86, s83, 196608
    buffer_load_dwordx4 v5, s[40:43], s86 offen lds
    s_add_u32 m0, s84, 8192
    s_add_u32 s86, s82, 81920
    buffer_load_dwordx4 v4, s[48:51], s86 offen sc1 lds
    s_add_u32 m0, s84, 28672
    s_add_u32 s86, s83, 294912
    buffer_load_dwordx4 v5, s[40:43], s86 offen lds
    s_add_u32 m0, s84, 12288
    s_add_u32 s86, s82, 122880
    buffer_load_dwordx4 v4, s[48:51], s86 offen sc1 lds
    s_add_u32 s82, s82, 163840
    s_add_u32 s83, s83, 393216
    s_add_u32 s80, s80, 36864
    s_cmp_eq_u32 s80, 147456
    s_cselect_b32 s80, 0, s80
    s_add_u32 s9, s9, 1
    s_cmp_eq_u32 s9, 8
    s_cselect_b32 s9, 0, s9
    s_cselect_b32 s87, 1310720, 0
    s_cselect_b32 s88, 3145728, 0
    s_sub_u32 s82, s82, s87
    s_sub_u32 s83, s83, s88
    s_add_u32 s11, s11, 1
    s_cmp_eq_u32 s11, 8
    s_cselect_b32 s87, 1310720, 0
    s_cselect_b32 s88, 3145728, 0
    s_add_u32 s82, s82, s87
    s_add_u32 s83, s83, s88
    s_waitcnt vmcnt(25)
    s_barrier
    s_lshl_b32 s84, s69, 10
    s_add_u32 s84, s84, s80
    s_add_u32 m0, s84, 16384
    s_add_u32 s86, s83, 0
    buffer_load_dwordx4 v5, s[40:43], s86 offen lds
    s_add_u32 m0, s84, 0
    s_add_u32 s86, s82, 0
    buffer_load_dwordx4 v4, s[48:51], s86 offen sc1 lds
    s_add_u32 m0, s84, 20480
    s_add_u32 s86, s83, 98304
    buffer_load_dwordx4 v5, s[40:43], s86 offen lds
    s_add_u32 m0, s84, 4096
    s_add_u32 s86, s82, 40960
    buffer_load_dwordx4 v4, s[48:51], s86 offen sc1 lds
    s_add_u32 m0, s84, 24576
    s_add_u32 s86, s83, 196608
    buffer_load_dwordx4 v5, s[40:43], s86 offen lds
    s_add_u32 m0, s84, 8192
    s_add_u32 s86, s82, 81920
    buffer_load_dwordx4 v4, s[48:51], s86 offen sc1 lds
    s_add_u32 m0, s84, 28672
    s_add_u32 s86, s83, 294912
    buffer_load_dwordx4 v5, s[40:43], s86 offen lds
    s_add_u32 m0, s84, 12288
    s_add_u32 s86, s82, 122880
    buffer_load_dwordx4 v4, s[48:51], s86 offen sc1 lds
    s_add_u32 s82, s82, 163840
    s_add_u32 s83, s83, 393216
    s_add_u32 s80, s80, 36864
    s_cmp_eq_u32 s80, 147456
    s_cselect_b32 s80, 0, s80
    s_add_u32 s9, s9, 1
    s_cmp_eq_u32 s9, 8
    s_cselect_b32 s9, 0, s9
    s_cselect_b32 s87, 1310720, 0
    s_cselect_b32 s88, 3145728, 0
    s_sub_u32 s82, s82, s87
    s_sub_u32 s83, s83, s88
    s_add_u32 s11, s11, 1
    s_cmp_eq_u32 s11, 8
    s_cselect_b32 s87, 1310720, 0
    s_cselect_b32 s88, 3145728, 0
    s_add_u32 s82, s82, s87
    s_add_u32 s83, s83, s88
    s_waitcnt vmcnt(16)
    s_barrier
    s_cmp_lg_u32 s69, 0
    s_cbranch_scc1 Lw0_1008
    s_lshl_b32 s90, s71, 4
    s_add_u32 s90, s90, s70
    s_lshl_b32 s90, s90, 2
    s_add_u32 s90, s90, 5120
    s_atomic_swap s77, s[48:49], s90
Lw0_1008:
    s_lshl_b32 s84, s69, 10
    s_add_u32 s84, s84, s80
    s_add_u32 m0, s84, 16384
    s_add_u32 s86, s83, 0
    buffer_load_dwordx4 v5, s[40:43], s86 offen lds
    s_add_u32 m0, s84, 0
    s_add_u32 s86, s82, 0
    buffer_load_dwordx4 v4, s[48:51], s86 offen sc1 lds
    s_add_u32 m0, s84, 20480
    s_add_u32 s86, s83, 98304
    buffer_load_dwordx4 v5, s[40:43], s86 offen lds
    s_add_u32 m0, s84, 4096
    s_add_u32 s86, s82, 40960
    buffer_load_dwordx4 v4, s[48:51], s86 offen sc1 lds
    s_add_u32 m0, s84, 24576
    s_add_u32 s86, s83, 196608
    buffer_load_dwordx4 v5, s[40:43], s86 offen lds
    s_add_u32 m0, s84, 8192
    s_add_u32 s86, s82, 81920
    buffer_load_dwordx4 v4, s[48:51], s86 offen sc1 lds
    s_add_u32 m0, s84, 28672
    s_add_u32 s86, s83, 294912
    buffer_load_dwordx4 v5, s[40:43], s86 offen lds
    s_add_u32 m0, s84, 12288
    s_add_u32 s86, s82, 122880
    buffer_load_dwordx4 v4, s[48:51], s86 offen sc1 lds
    s_add_u32 s82, s82, 163840
    s_add_u32 s83, s83, 393216
    s_add_u32 s80, s80, 36864
    s_cmp_eq_u32 s80, 147456
    s_cselect_b32 s80, 0, s80
    s_add_u32 s9, s9, 1
    s_cmp_eq_u32 s9, 8
    s_cselect_b32 s9, 0, s9
    s_cselect_b32 s87, 1310720, 0
    s_cselect_b32 s88, 3145728, 0
    s_sub_u32 s82, s82, s87
    s_sub_u32 s83, s83, s88
    s_add_u32 s11, s11, 1
    s_cmp_eq_u32 s11, 8
    s_cselect_b32 s87, 1310720, 0
    s_cselect_b32 s88, 3145728, 0
    s_add_u32 s82, s82, s87
    s_add_u32 s83, s83, s88
    s_mov_b32 s81, 7
Lloop_1009:
    s_waitcnt vmcnt(16)
    s_barrier
    s_lshl_b32 s84, s69, 10
    s_add_u32 s84, s84, s80
    s_add_u32 m0, s84, 16384
    s_add_u32 s86, s83, 0
    buffer_load_dwordx4 v5, s[40:43], s86 offen lds
    s_add_u32 m0, s84, 0
    s_add_u32 s86, s82, 0
    buffer_load_dwordx4 v4, s[48:51], s86 offen sc1 lds
    s_add_u32 m0, s84, 20480
    s_add_u32 s86, s83, 98304
    buffer_load_dwordx4 v5, s[40:43], s86 offen lds
    s_add_u32 m0, s84, 4096
    s_add_u32 s86, s82, 40960
    buffer_load_dwordx4 v4, s[48:51], s86 offen sc1 lds
    s_add_u32 m0, s84, 24576
    s_add_u32 s86, s83, 196608
    buffer_load_dwordx4 v5, s[40:43], s86 offen lds
    s_add_u32 m0, s84, 8192
    s_add_u32 s86, s82, 81920
    buffer_load_dwordx4 v4, s[48:51], s86 offen sc1 lds
    s_add_u32 m0, s84, 28672
    s_add_u32 s86, s83, 294912
    buffer_load_dwordx4 v5, s[40:43], s86 offen lds
    s_add_u32 m0, s84, 12288
    s_add_u32 s86, s82, 122880
    buffer_load_dwordx4 v4, s[48:51], s86 offen sc1 lds
    s_add_u32 s82, s82, 163840
    s_add_u32 s83, s83, 393216
    s_add_u32 s80, s80, 36864
    s_cmp_eq_u32 s80, 147456
    s_cselect_b32 s80, 0, s80
    s_add_u32 s9, s9, 1
    s_cmp_eq_u32 s9, 8
    s_cselect_b32 s9, 0, s9
    s_cselect_b32 s87, 1310720, 0
    s_cselect_b32 s88, 3145728, 0
    s_sub_u32 s82, s82, s87
    s_sub_u32 s83, s83, s88
    s_add_u32 s11, s11, 1
    s_cmp_eq_u32 s11, 8
    s_cselect_b32 s87, 1310720, 0
    s_cselect_b32 s88, 3145728, 0
    s_add_u32 s82, s82, s87
    s_add_u32 s83, s83, s88
    s_sub_u32 s81, s81, 1
    s_cmp_lg_u32 s81, 0
    s_cbranch_scc1 Lloop_1009
    s_waitcnt vmcnt(16)
    s_barrier
    buffer_load_dword v24, v15, s[48:51], 0 offen sc1
    s_lshl_b32 s84, s69, 10
    s_add_u32 s84, s84, s80
    s_add_u32 m0, s84, 16384
    s_add_u32 s86, s83, 0
    buffer_load_dwordx4 v5, s[40:43], s86 offen lds
    s_add_u32 m0, s84, 0
    s_add_u32 s86, s82, 0
    buffer_load_dwordx4 v4, s[48:51], s86 offen sc1 lds
    s_add_u32 m0, s84, 20480
    s_add_u32 s86, s83, 98304
    buffer_load_dwordx4 v5, s[40:43], s86 offen lds
    s_add_u32 m0, s84, 4096
    s_add_u32 s86, s82, 40960
    buffer_load_dwordx4 v4, s[48:51], s86 offen sc1 lds
    s_add_u32 m0, s84, 24576
    s_add_u32 s86, s83, 196608
    buffer_load_dwordx4 v5, s[40:43], s86 offen lds
    s_add_u32 m0, s84, 8192
    s_add_u32 s86, s82, 81920
    buffer_load_dwordx4 v4, s[48:51], s86 offen sc1 lds
    s_add_u32 m0, s84, 28672
    s_add_u32 s86, s83, 294912
    buffer_load_dwordx4 v5, s[40:43], s86 offen lds
    s_add_u32 m0, s84, 12288
    s_add_u32 s86, s82, 122880
    buffer_load_dwordx4 v4, s[48:51], s86 offen sc1 lds
    s_add_u32 s82, s82, 163840
    s_add_u32 s83, s83, 393216
    s_add_u32 s80, s80, 36864
    s_cmp_eq_u32 s80, 147456
    s_cselect_b32 s80, 0, s80
    s_add_u32 s9, s9, 1
    s_cmp_eq_u32 s9, 8
    s_cselect_b32 s9, 0, s9
    s_cselect_b32 s87, 1310720, 0
    s_cselect_b32 s88, 3145728, 0
    s_sub_u32 s82, s82, s87
    s_sub_u32 s83, s83, s88
    s_add_u32 s11, s11, 1
    s_cmp_eq_u32 s11, 8
    s_cselect_b32 s87, 1310720, 0
    s_cselect_b32 s88, 3145728, 0
    s_add_u32 s82, s82, s87
    s_add_u32 s83, s83, s88
    s_waitcnt vmcnt(17)
    s_barrier
    s_lshl_b32 s84, s69, 10
    s_add_u32 s84, s84, s80
    s_add_u32 m0, s84, 16384
    s_add_u32 s86, s83, 0
    buffer_load_dwordx4 v5, s[40:43], s86 offen lds
    s_add_u32 m0, s84, 0
    s_add_u32 s86, s82, 0
    buffer_load_dwordx4 v4, s[48:51], s86 offen sc1 lds
    s_add_u32 m0, s84, 20480
    s_add_u32 s86, s83, 98304
    buffer_load_dwordx4 v5, s[40:43], s86 offen lds
    s_add_u32 m0, s84, 4096
    s_add_u32 s86, s82, 40960
    buffer_load_dwordx4 v4, s[48:51], s86 offen sc1 lds
    s_add_u32 m0, s84, 24576
    s_add_u32 s86, s83, 196608
    buffer_load_dwordx4 v5, s[40:43], s86 offen lds
    s_add_u32 m0, s84, 8192
    s_add_u32 s86, s82, 81920
    buffer_load_dwordx4 v4, s[48:51], s86 offen sc1 lds
    s_add_u32 m0, s84, 28672
    s_add_u32 s86, s83, 294912
    buffer_load_dwordx4 v5, s[40:43], s86 offen lds
    s_add_u32 m0, s84, 12288
    s_add_u32 s86, s82, 122880
    buffer_load_dwordx4 v4, s[48:51], s86 offen sc1 lds
    s_add_u32 s82, s82, 163840
    s_add_u32 s83, s83, 393216
    s_add_u32 s80, s80, 36864
    s_cmp_eq_u32 s80, 147456
    s_cselect_b32 s80, 0, s80
    s_add_u32 s9, s9, 1
    s_cmp_eq_u32 s9, 8
    s_cselect_b32 s9, 0, s9
    s_cselect_b32 s87, 1310720, 0
    s_cselect_b32 s88, 3145728, 0
    s_sub_u32 s82, s82, s87
    s_sub_u32 s83, s83, s88
    s_add_u32 s11, s11, 1
    s_cmp_eq_u32 s11, 8
    s_cselect_b32 s87, 1310720, 0
    s_cselect_b32 s88, 3145728, 0
    s_add_u32 s82, s82, s87
    s_add_u32 s83, s83, s88
    s_waitcnt vmcnt(17)
    s_barrier
    s_lshl_b32 s84, s69, 10
    s_add_u32 s84, s84, s80
    s_add_u32 m0, s84, 16384
    s_add_u32 s86, s83, 0
    buffer_load_dwordx4 v5, s[40:43], s86 offen lds
    s_add_u32 m0, s84, 0
    s_add_u32 s86, s82, 0
    buffer_load_dwordx4 v4, s[48:51], s86 offen sc1 lds
    s_add_u32 m0, s84, 20480
    s_add_u32 s86, s83, 98304
    buffer_load_dwordx4 v5, s[40:43], s86 offen lds
    s_add_u32 m0, s84, 4096
    s_add_u32 s86, s82, 40960
    buffer_load_dwordx4 v4, s[48:51], s86 offen sc1 lds
    s_add_u32 m0, s84, 24576
    s_add_u32 s86, s83, 196608
    buffer_load_dwordx4 v5, s[40:43], s86 offen lds
    s_add_u32 m0, s84, 8192
    s_add_u32 s86, s82, 81920
    buffer_load_dwordx4 v4, s[48:51], s86 offen sc1 lds
    s_add_u32 m0, s84, 28672
    s_add_u32 s86, s83, 294912
    buffer_load_dwordx4 v5, s[40:43], s86 offen lds
    s_add_u32 m0, s84, 12288
    s_add_u32 s86, s82, 122880
    buffer_load_dwordx4 v4, s[48:51], s86 offen sc1 lds
    s_add_u32 s82, s82, 163840
    s_add_u32 s83, s83, 393216
    s_add_u32 s80, s80, 36864
    s_cmp_eq_u32 s80, 147456
    s_cselect_b32 s80, 0, s80
    s_add_u32 s9, s9, 1
    s_cmp_eq_u32 s9, 8
    s_cselect_b32 s9, 0, s9
    s_cselect_b32 s87, 1310720, 0
    s_cselect_b32 s88, 3145728, 0
    s_sub_u32 s82, s82, s87
    s_sub_u32 s83, s83, s88
    s_add_u32 s11, s11, 1
    s_cmp_eq_u32 s11, 8
    s_cselect_b32 s87, 1310720, 0
    s_cselect_b32 s88, 3145728, 0
    s_add_u32 s82, s82, s87
    s_add_u32 s83, s83, s88
    s_waitcnt vmcnt(16)
    s_cmp_lg_u32 s69, 0
    s_cbranch_scc1 Lw0_1010
    v_cmp_eq_u32 s[86:87], s77, v24
    s_nop 3
    s_cmp_eq_u64 s[86:87], exec
    s_cbranch_scc1 Lpok_1011
    s_mov_b32 s85, 100000
Lspin_1012:
    s_sleep 2
    buffer_load_dword v24, v15, s[48:51], 0 offen sc1
    s_waitcnt vmcnt(0)
    v_cmp_eq_u32 s[86:87], s77, v24
    s_nop 3
    s_cmp_eq_u64 s[86:87], exec
    s_cbranch_scc1 Lpok_1011
    s_sub_u32 s85, s85, 1
    s_cmp_lg_u32 s85, 0
    s_cbranch_scc1 Lspin_1012
Lpok_1011:
Lw0_1010:
    s_barrier
    s_lshl_b32 s82, s71, 11
    s_lshl_b32 s86, s70, 7
    s_add_u32 s82, s82, s86
    s_mul_i32 s82, s82, 168
    s_add_u32 s82, s82, 5265408
    s_lshl_b32 s86, s69, 10
    s_add_u32 s82, s82, s86
    s_add_u32 s84, s86, 73728
    s_add_u32 m0, s84, 0
    s_add_u32 s86, s82, 0
    buffer_load_dwordx4 v6, s[48:51], s86 offen sc1 lds
    s_add_u32 m0, s84, 4096
    s_add_u32 s86, s82, 4096
    buffer_load_dwordx4 v6, s[48:51], s86 offen sc1 lds
    s_add_u32 m0, s84, 8192
    s_add_u32 s86, s82, 8192
    buffer_load_dwordx4 v6, s[48:51], s86 offen sc1 lds
    s_add_u32 m0, s84, 12288
    s_add_u32 s86, s82, 12288
    buffer_load_dwordx4 v6, s[48:51], s86 offen sc1 lds
    s_add_u32 m0, s84, 16384
    s_add_u32 s86, s82, 16384
    buffer_load_dwordx4 v6, s[48:51], s86 offen sc1 lds
    s_add_u32 m0, s84, 20480
    s_add_u32 s86, s82, 20480
    buffer_load_dwordx4 v6, s[48:51], s86 offen sc1 lds
    s_add_u32 m0, s84, 24576
    s_add_u32 s86, s82, 24576
    buffer_load_dwordx4 v6, s[48:51], s86 offen sc1 lds
    s_add_u32 m0, s84, 28672
    s_add_u32 s86, s82, 28672
    buffer_load_dwordx4 v6, s[48:51], s86 offen sc1 lds
    s_add_u32 m0, s84, 32768
    s_add_u32 s86, s82, 32768
    buffer_load_dwordx4 v6, s[48:51], s86 offen sc1 lds
    s_waitcnt vmcnt(17)
    s_barrier
    s_add_u32 m0, s84, 36864
    s_add_u32 s86, s82, 36864
    buffer_load_dwordx4 v6, s[48:51], s86 offen sc1 lds
    s_add_u32 m0, s84, 40960
    s_add_u32 s86, s82, 40960
    buffer_load_dwordx4 v6, s[48:51], s86 offen sc1 lds
    s_add_u32 m0, s84, 45056
    s_add_u32 s86, s82, 45056
    buffer_load_dwordx4 v6, s[48:51], s86 offen sc1 lds
    s_add_u32 m0, s84, 49152
    s_add_u32 s86, s82, 49152
    buffer_load_dwordx4 v6, s[48:51], s86 offen sc1 lds
    s_add_u32 m0, s84, 53248
    s_add_u32 s86, s82, 53248
    buffer_load_dwordx4 v6, s[48:51], s86 offen sc1 lds
    s_add_u32 m0, s84, 57344
    s_add_u32 s86, s82, 57344
    buffer_load_dwordx4 v6, s[48:51], s86 offen sc1 lds
    s_add_u32 m0, s84, 61440
    s_add_u32 s86, s82, 61440
    buffer_load_dwordx4 v6, s[48:51], s86 offen sc1 lds
    s_waitcnt vmcnt(16)
    s_barrier
    s_mul_i32 s83, s69, 32768
    s_lshl_b32 s86, s74, 7
    s_add_u32 s83, s83, s86
    s_mul_i32 s82, s75, 245760
    s_lshl_b32 s86, s69, 10
    s_add_u32 s82, s82, s86
    s_add_u32 s82, s82, 10878976
    s_mov_b32 s16, s82
    s_mov_b32 s17, s83
    s_mov_b32 s9, 0
    s_mov_b32 s10, 0
    s_lshr_b32 s86, s76, 3
    s_lshr_b32 s87, s86, 3
    s_add_u32 s86, s86, s87
    s_and_b32 s14, s86, 3
    s_mov_b32 s80, 0
    s_barrier
    s_waitcnt vmcnt(0)
    s_barrier
    s_cmp_lg_u32 s69, 0
    s_cbranch_scc1 Lw0_1013
    v_lshrrev_b32 v28, 3, v0
    v_and_b32 v29, 7, v0
    v_mul_u32_u24 v30, 144, v28
    v_lshl_add_u32 v30, v29, 4, v30
    v_add_u32 v30, 36864, v30
    ds_read_b128 v[32:35], v30 offset:0
    ds_read_b128 v[36:39], v30 offset:1152
    ds_read_b128 v[40:43], v30 offset:2304
    ds_read_b128 v[44:47], v30 offset:3456
    ds_read_b128 v[48:51], v30 offset:4608
    ds_read_b128 v[52:55], v30 offset:5760
    ds_read_b128 v[56:59], v30 offset:6912
    ds_read_b128 v[60:63], v30 offset:8064
    s_lshl_b32 s86, s72, 6
    v_lshl_add_u32 v29, v29, 3, s86
    v_mul_u32_u24 v31, 820, v29
    v_lshrrev_b32 v31, 16, v31
    v_mul_u32_u24 v30, 80, v31
    v_sub_u32 v29, v29, v30
    v_mul_u32_u24 v31, 245760, v31
    v_lshl_add_u32 v31, v29, 1, v31
    s_lshl_b32 s86, s73, 6
    v_add_u32 v28, s86, v28
    v_mul_u32_u24 v28, 160, v28
    v_add_u32 v31, v31, v28
    s_mov_b32 s87, 10878976
    s_cmp_eq_u32 s78, 0
    s_cselect_b32 s86, 2146435072, s87
    s_waitcnt lgkmcnt(7)
    buffer_store_dwordx4 v[32:35], v31, s[48:51], s86 offen sc1
    s_add_u32 s86, s86, 1280
    s_waitcnt lgkmcnt(6)
    buffer_store_dwordx4 v[36:39], v31, s[48:51], s86 offen sc1
    s_add_u32 s86, s86, 1280
    s_waitcnt lgkmcnt(5)
    buffer_store_dwordx4 v[40:43], v31, s[48:51], s86 offen sc1
    s_add_u32 s86, s86, 1280
    s_waitcnt lgkmcnt(4)
    buffer_store_dwordx4 v[44:47], v31, s[48:51], s86 offen sc1
    s_add_u32 s86, s86, 1280
    s_waitcnt lgkmcnt(3)
    buffer_store_dwordx4 v[48:51], v31, s[48:51], s86 offen sc1
    s_add_u32 s86, s86, 1280
    s_waitcnt lgkmcnt(2)
    buffer_store_dwordx4 v[52:55], v31, s[48:51], s86 offen sc1
    s_add_u32 s86, s86, 1280
    s_waitcnt lgkmcnt(1)
    buffer_store_dwordx4 v[56:59], v31, s[48:51], s86 offen sc1
    s_add_u32 s86, s86, 1280
    s_waitcnt lgkmcnt(0)
    buffer_store_dwordx4 v[60:63], v31, s[48:51], s86 offen sc1
    v_mov_b32 v20, 158208
    v_mov_b32 v21, 4
    ds_write_b32 v20, v21
    s_waitcnt vmcnt(0)
    s_cmp_eq_u32 s78, 0
    s_cbranch_scc1 Lgidle_1014
    s_lshl_b32 s90, s73, 6
    s_lshl_b32 s91, s72, 2
    s_add_u32 s90, s90, s91
    s_add_u32 s90, s90, 32768
    s_atomic_swap s77, s[48:49], s90
    s_add_u32 s90, s90, 1536
    s_atomic_swap s77, s[48:49], s90
    s_add_u32 s90, s90, 1536
    s_atomic_swap s77, s[48:49], s90
    s_add_u32 s90, s90, 1536
    s_atomic_swap s77, s[48:49], s90
    s_add_u32 s90, s90, 1536
    s_atomic_swap s77, s[48:49], s90
    s_add_u32 s90, s90, 1536
    s_atomic_swap s77, s[48:49], s90
    s_add_u32 s90, s90, 1536
    s_atomic_swap s77, s[48:49], s90
    s_add_u32 s90, s90, 1536
    s_atomic_swap s77, s[48:49], s90
Lgidle_1014:
Lw0_1013:
    v_mov_b32 v25, 158208
    s_mov_b32 s85, 100000
Llspin_1016:
    ds_read_b32 v24, v25
    s_waitcnt lgkmcnt(0)
    v_readfirstlane_b32 s86, v24
    s_nop 3
    s_cmp_ge_u32 s86, 4
    s_cbranch_scc1 Llok_1015
    s_sleep 1
    s_sub_u32 s85, s85, 1
    s_cmp_lg_u32 s85, 0
    s_cbranch_scc1 Llspin_1016
Llok_1015:
    s_mul_i32 s86, s76, 24576
    s_mul_i32 s87, s69, 6144
    s_add_u32 s86, s86, s87
    s_add_u32 s86, s86, 0
    buffer_load_dwordx4 v[96:99], v6, s[44:47], s86 offen offset:0
    buffer_load_dwordx4 v[96:99], v6, s[44:47], s86 offen offset:1024
    buffer_load_dwordx4 v[96:99], v6, s[44:47], s86 offen offset:2048
    buffer_load_dwordx4 v[96:99], v6, s[44:47], s86 offen offset:3072
    s_add_u32 s86, s86, 4096
    buffer_load_dwordx4 v[96:99], v6, s[44:47], s86 offen offset:0
    buffer_load_dwordx4 v[96:99], v6, s[44:47], s86 offen offset:1024
    s_mul_i32 s86, s76, 3200
    s_mul_i32 s87, s69, 1024
    s_add_u32 s86, s86, s87
    s_add_u32 s86, s86, 0
    buffer_load_dwordx4 v[96:99], v6, s[36:39], s86 offen offset:0
    s_lshl_b32 s84, s69, 10
    s_add_u32 s84, s84, s80
    s_add_u32 s87, s10, s14
    s_and_b32 s87, s87, 3
    s_mul_i32 s87, s87, 3
    s_lshr_b32 s88, s10, 2
    s_add_u32 s87, s87, s88
    s_mul_i32 s87, s87, 524288
    s_add_u32 s83, s17, s87
    s_add_u32 s10, s10, 1
    s_add_u32 m0, s84, 0
    s_add_u32 s86, s83, 0
    buffer_load_dwordx4 v7, s[44:47], s86 offen lds
    s_add_u32 m0, s84, 4096
    s_add_u32 s86, s83, 131072
    buffer_load_dwordx4 v7, s[44:47], s86 offen lds
    s_add_u32 m0, s84, 8192
    s_add_u32 s86, s83, 262144
    buffer_load_dwordx4 v7, s[44:47], s86 offen lds
    s_add_u32 m0, s84, 12288
    s_add_u32 s86, s83, 393216
    buffer_load_dwordx4 v7, s[44:47], s86 offen lds
    s_add_u32 s83, s83, 524288
    s_add_u32 s84, s84, 36864
    s_add_u32 s87, s10, s14
    s_and_b32 s87, s87, 3
    s_mul_i32 s87, s87, 3
    s_lshr_b32 s88, s10, 2
    s_add_u32 s87, s87, s88
    s_mul_i32 s87, s87, 524288
    s_add_u32 s83, s17, s87
    s_add_u32 s10, s10, 1
    s_add_u32 m0, s84, 0
    s_add_u32 s86, s83, 0
    buffer_load_dwordx4 v7, s[44:47], s86 offen lds
    s_add_u32 m0, s84, 4096
    s_add_u32 s86, s83, 131072
    buffer_load_dwordx4 v7, s[44:47], s86 offen lds
    s_add_u32 m0, s84, 8192
    s_add_u32 s86, s83, 262144
    buffer_load_dwordx4 v7, s[44:47], s86 offen lds
    s_add_u32 m0, s84, 12288
    s_add_u32 s86, s83, 393216
    buffer_load_dwordx4 v7, s[44:47], s86 offen lds
    s_add_u32 s83, s83, 524288
    s_cmp_lg_u32 s69, 0
    s_cbranch_scc1 Lw0_1017
    s_mov_b32 s85, 100000
Lgspin_1019:
    s_sleep 4
    buffer_load_dword v24, v14, s[48:51], 0 offen sc1
    s_waitcnt vmcnt(0)
    v_cmp_eq_u32 s[86:87], s77, v24
    s_nop 3
    s_cmp_eq_u64 s[86:87], exec
    s_cbranch_scc1 Lgok_1018
    s_sub_u32 s85, s85, 1
    s_cmp_lg_u32 s85, 0
    s_cbranch_scc1 Lgspin_1019
Lgok_1018:
    v_mov_b32 v20, 158212
    v_mov_b32 v21, 1
    ds_write_b32 v20, v21
Lw0_1017:
    v_mov_b32 v25, 158212
    s_mov_b32 s85, 100000
Llspin_1021:
    ds_read_b32 v24, v25
    s_waitcnt lgkmcnt(0)
    v_readfirstlane_b32 s86, v24
    s_nop 3
    s_cmp_ge_u32 s86, 1
    s_cbranch_scc1 Llok_1020
    s_sleep 1
    s_sub_u32 s85, s85, 1
    s_cmp_lg_u32 s85, 0
    s_cbranch_scc1 Llspin_1021
Llok_1020:
    s_lshl_b32 s84, s69, 10
    s_add_u32 s84, s84, s80
    s_add_u32 s87, s9, s14
    s_and_b32 s87, s87, 3
    s_mul_i32 s87, s87, 3
    s_lshr_b32 s88, s9, 2
    s_add_u32 s87, s87, s88
    s_mul_i32 s87, s87, 20480
    s_add_u32 s82, s16, s87
    s_add_u32 s9, s9, 1
    s_add_u32 m0, s84, 16384
    s_add_u32 s86, s82, 0
    buffer_load_dwordx4 v6, s[48:51], s86 offen sc1 lds
    s_add_u32 m0, s84, 20480
    s_add_u32 s86, s82, 4096
    buffer_load_dwordx4 v6, s[48:51], s86 offen sc1 lds
    s_add_u32 m0, s84, 24576
    s_add_u32 s86, s82, 8192
    buffer_load_dwordx4 v6, s[48:51], s86 offen sc1 lds
    s_add_u32 m0, s84, 28672
    s_add_u32 s86, s82, 12288
    buffer_load_dwordx4 v6, s[48:51], s86 offen sc1 lds
    s_add_u32 m0, s84, 32768
    s_add_u32 s86, s82, 16384
    buffer_load_dwordx4 v6, s[48:51], s86 offen sc1 lds
    s_add_u32 s82, s82, 20480
    s_add_u32 s84, s84, 36864
    s_add_u32 s87, s9, s14
    s_and_b32 s87, s87, 3
    s_mul_i32 s87, s87, 3
    s_lshr_b32 s88, s9, 2
    s_add_u32 s87, s87, s88
    s_mul_i32 s87, s87, 20480
    s_add_u32 s82, s16, s87
    s_add_u32 s9, s9, 1
    s_add_u32 m0, s84, 16384
    s_add_u32 s86, s82, 0
    buffer_load_dwordx4 v6, s[48:51], s86 offen sc1 lds
    s_add_u32 m0, s84, 20480
    s_add_u32 s86, s82, 4096
    buffer_load_dwordx4 v6, s[48:51], s86 offen sc1 lds
    s_add_u32 m0, s84, 24576
    s_add_u32 s86, s82, 8192
    buffer_load_dwordx4 v6, s[48:51], s86 offen sc1 lds
    s_add_u32 m0, s84, 28672
    s_add_u32 s86, s82, 12288
    buffer_load_dwordx4 v6, s[48:51], s86 offen sc1 lds
    s_add_u32 m0, s84, 32768
    s_add_u32 s86, s82, 16384
    buffer_load_dwordx4 v6, s[48:51], s86 offen sc1 lds
    s_add_u32 s82, s82, 20480
    s_mov_b32 s80, 73728
    buffer_load_dword v24, v16, s[48:51], 0 offen sc1
    s_waitcnt vmcnt(6)
    s_barrier
    s_lshl_b32 s84, s69, 10
    s_add_u32 s84, s84, s80
    s_add_u32 s87, s10, s14
    s_and_b32 s87, s87, 3
    s_mul_i32 s87, s87, 3
    s_lshr_b32 s88, s10, 2
    s_add_u32 s87, s87, s88
    s_mul_i32 s87, s87, 524288
    s_add_u32 s83, s17, s87
    s_add_u32 s10, s10, 1
    s_add_u32 m0, s84, 0
    s_add_u32 s86, s83, 0
    buffer_load_dwordx4 v7, s[44:47], s86 offen lds
    s_add_u32 m0, s84, 4096
    s_add_u32 s86, s83, 131072
    buffer_load_dwordx4 v7, s[44:47], s86 offen lds
    s_add_u32 m0, s84, 8192
    s_add_u32 s86, s83, 262144
    buffer_load_dwordx4 v7, s[44:47], s86 offen lds
    s_add_u32 m0, s84, 12288
    s_add_u32 s86, s83, 393216
    buffer_load_dwordx4 v7, s[44:47], s86 offen lds
    s_add_u32 s83, s83, 524288
    s_add_u32 s87, s9, s14
    s_and_b32 s87, s87, 3
    s_mul_i32 s87, s87, 3
    s_lshr_b32 s88, s9, 2
    s_add_u32 s87, s87, s88
    s_mul_i32 s87, s87, 20480
    s_add_u32 s82, s16, s87
    s_add_u32 s9, s9, 1
    s_add_u32 m0, s84, 16384
    s_add_u32 s86, s82, 0
    buffer_load_dwordx4 v6, s[48:51], s86 offen sc1 lds
    s_add_u32 m0, s84, 20480
    s_add_u32 s86, s82, 4096
    buffer_load_dwordx4 v6, s[48:51], s86 offen sc1 lds
    s_add_u32 m0, s84, 24576
    s_add_u32 s86, s82, 8192
    buffer_load_dwordx4 v6, s[48:51], s86 offen sc1 lds
    s_add_u32 m0, s84, 28672
    s_add_u32 s86, s82, 12288
    buffer_load_dwordx4 v6, s[48:51], s86 offen sc1 lds
    s_add_u32 m0, s84, 32768
    s_add_u32 s86, s82, 16384
    buffer_load_dwordx4 v6, s[48:51], s86 offen sc1 lds
    s_add_u32 s82, s82, 20480
    s_add_u32 s80, s80, 36864
    s_cmp_eq_u32 s80, 147456
    s_cselect_b32 s80, 0, s80
    s_lshl_b32 s84, s69, 10
    s_add_u32 s84, s84, s80
    s_add_u32 s87, s10, s14
    s_and_b32 s87, s87, 3
    s_mul_i32 s87, s87, 3
    s_lshr_b32 s88, s10, 2
    s_add_u32 s87, s87, s88
    s_mul_i32 s87, s87, 524288
    s_add_u32 s83, s17, s87
    s_add_u32 s10, s10, 1
    s_add_u32 m0, s84, 0
    s_add_u32 s86, s83, 0
    buffer_load_dwordx4 v7, s[44:47], s86 offen lds
    s_add_u32 m0, s84, 4096
    s_add_u32 s86, s83, 131072
    buffer_load_dwordx4 v7, s[44:47], s86 offen lds
    s_add_u32 m0, s84, 8192
    s_add_u32 s86, s83, 262144
    buffer_load_dwordx4 v7, s[44:47], s86 offen lds
    s_add_u32 m0, s84, 12288
    s_add_u32 s86, s83, 393216
    buffer_load_dwordx4 v7, s[44:47], s86 offen lds
    s_add_u32 s83, s83, 524288
    s_add_u32 s87, s9, s14
    s_and_b32 s87, s87, 3
    s_mul_i32 s87, s87, 3
    s_lshr_b32 s88, s9, 2
    s_add_u32 s87, s87, s88
    s_mul_i32 s87, s87, 20480
    s_add_u32 s82, s16, s87
    s_add_u32 s9, s9, 1
    s_add_u32 m0, s84, 16384
    s_add_u32 s86, s82, 0
    buffer_load_dwordx4 v6, s[48:51], s86 offen sc1 lds
    s_add_u32 m0, s84, 20480
    s_add_u32 s86, s82, 4096
    buffer_load_dwordx4 v6, s[48:51], s86 offen sc1 lds
    s_add_u32 m0, s84, 24576
    s_add_u32 s86, s82, 8192
    buffer_load_dwordx4 v6, s[48:51], s86 offen sc1 lds
    s_add_u32 m0, s84, 28672
    s_add_u32 s86, s82, 12288
    buffer_load_dwordx4 v6, s[48:51], s86 offen sc1 lds
    s_add_u32 m0, s84, 32768
    s_add_u32 s86, s82, 16384
    buffer_load_dwordx4 v6, s[48:51], s86 offen sc1 lds
    s_add_u32 s82, s82, 20480
    s_add_u32 s80, s80, 36864
    s_cmp_eq_u32 s80, 147456
    s_cselect_b32 s80, 0, s80
    s_lshl_b32 s86, s70, 7
    s_mul_i32 s86, s86, 1280
    s_mul_i32 s87, s71, 80
    s_add_u32 s86, s86, s87
    s_add_u32 s86, s86, 12845056
    s_lshl_b32 s87, s69, 6
    v_add_u32 v28, s87, v0
    v_lshlrev_b32 v29, 4, v28
    v_add_u32 v29, 147456, v29
    ds_read_b128 v[40:43], v29 offset:0
    ds_read_b128 v[44:47], v29 offset:4096
    ds_read_b128 v[48:51], v29 offset:8192
    v_add_u32 v30, 0, v28
    v_mul_u32_u24 v31, 13108, v30
    v_lshrrev_b32 v31, 16, v31
    v_mul_u32_u24 v32, 5, v31
    v_sub_u32 v32, v30, v32
    v_mul_u32_u24 v31, 1280, v31
    v_lshl_add_u32 v31, v32, 4, v31
    v_add_u32 v33, s86, v31
    v_add_u32 v30, 256, v28
    v_mul_u32_u24 v31, 13108, v30
    v_lshrrev_b32 v31, 16, v31
    v_mul_u32_u24 v32, 5, v31
    v_sub_u32 v32, v30, v32
    v_mul_u32_u24 v31, 1280, v31
    v_lshl_add_u32 v31, v32, 4, v31
    v_add_u32 v34, s86, v31
    v_add_u32 v30, 512, v28
    v_mul_u32_u24 v31, 13108, v30
    v_lshrrev_b32 v31, 16, v31
    v_mul_u32_u24 v32, 5, v31
    v_sub_u32 v32, v30, v32
    v_mul_u32_u24 v31, 1280, v31
    v_lshl_add_u32 v31, v32, 4, v31
    v_add_u32 v35, s86, v31
    v_mov_b32 v30, 2146435072
    v_add_u32 v31, 512, v28
    v_cmp_gt_u32 vcc, 640, v31
    s_nop 1
    v_cndmask_b32 v35, v30, v35, vcc
    s_waitcnt lgkmcnt(0)
    buffer_store_dwordx4 v[40:43], v33, s[48:51], 0 offen sc1
    buffer_store_dwordx4 v[44:47], v34, s[48:51], 0 offen sc1
    buffer_store_dwordx4 v[48:51], v35, s[48:51], 0 offen sc1
    s_waitcnt vmcnt(21)
    s_cmp_lg_u32 s69, 0
    s_cbranch_scc1 Lw0_1022
    v_cmp_eq_u32 s[86:87], s77, v24
    s_nop 3
    s_cmp_eq_u64 s[86:87], exec
    s_cbranch_scc1 Lpok_1023
    s_mov_b32 s85, 100000
Lspin_1024:
    s_sleep 2
    buffer_load_dword v24, v16, s[48:51], 0 offen sc1
    s_waitcnt vmcnt(0)
    v_cmp_eq_u32 s[86:87], s77, v24
    s_nop 3
    s_cmp_eq_u64 s[86:87], exec
    s_cbranch_scc1 Lpok_1023
    s_sub_u32 s85, s85, 1
    s_cmp_lg_u32 s85, 0
    s_cbranch_scc1 Lspin_1024
Lpok_1023:
Lw0_1022:
    s_barrier
    s_lshl_b32 s84, s69, 10
    s_add_u32 s84, s84, s80
    s_add_u32 s87, s10, s14
    s_and_b32 s87, s87, 3
    s_mul_i32 s87, s87, 3
    s_lshr_b32 s88, s10, 2
    s_add_u32 s87, s87, s88
    s_mul_i32 s87, s87, 524288
    s_add_u32 s83, s17, s87
    s_add_u32 s10, s10, 1
    s_add_u32 m0, s84, 0
    s_add_u32 s86, s83, 0
    buffer_load_dwordx4 v7, s[44:47], s86 offen lds
    s_add_u32 m0, s84, 4096
    s_add_u32 s86, s83, 131072
    buffer_load_dwordx4 v7, s[44:47], s86 offen lds
    s_add_u32 m0, s84, 8192
    s_add_u32 s86, s83, 262144
    buffer_load_dwordx4 v7, s[44:47], s86 offen lds
    s_add_u32 m0, s84, 12288
    s_add_u32 s86, s83, 393216
    buffer_load_dwordx4 v7, s[44:47], s86 offen lds
    s_add_u32 s83, s83, 524288
    s_add_u32 s87, s9, s14
    s_and_b32 s87, s87, 3
    s_mul_i32 s87, s87, 3
    s_lshr_b32 s88, s9, 2
    s_add_u32 s87, s87, s88
    s_mul_i32 s87, s87, 20480
    s_add_u32 s82, s16, s87
    s_add_u32 s9, s9, 1
    s_add_u32 m0, s84, 16384
    s_add_u32 s86, s82, 0
    buffer_load_dwordx4 v6, s[48:51], s86 offen sc1 lds
    s_add_u32 m0, s84, 20480
    s_add_u32 s86, s82, 4096
    buffer_load_dwordx4 v6, s[48:51], s86 offen sc1 lds
    s_add_u32 m0, s84, 24576
    s_add_u32 s86, s82, 8192
    buffer_load_dwordx4 v6, s[48:51], s86 offen sc1 lds
    s_add_u32 m0, s84, 28672
    s_add_u32 s86, s82, 12288
    buffer_load_dwordx4 v6, s[48:51], s86 offen sc1 lds
    s_add_u32 m0, s84, 32768
    s_add_u32 s86, s82, 16384
    buffer_load_dwordx4 v6, s[48:51], s86 offen sc1 lds
    s_add_u32 s82, s82, 20480
    s_add_u32 s80, s80, 36864
    s_cmp_eq_u32 s80, 147456
    s_cselect_b32 s80, 0, s80
    s_waitcnt vmcnt(21)
    s_barrier
    s_lshl_b32 s84, s69, 10
    s_add_u32 s84, s84, s80
    s_add_u32 s87, s10, s14
    s_and_b32 s87, s87, 3
    s_mul_i32 s87, s87, 3
    s_lshr_b32 s88, s10, 2
    s_add_u32 s87, s87, s88
    s_mul_i32 s87, s87, 524288
    s_add_u32 s83, s17, s87
    s_add_u32 s10, s10, 1
    s_add_u32 m0, s84, 0
    s_add_u32 s86, s83, 0
    buffer_load_dwordx4 v7, s[44:47], s86 offen lds
    s_add_u32 m0, s84, 4096
    s_add_u32 s86, s83, 131072
    buffer_load_dwordx4 v7, s[44:47], s86 offen lds
    s_add_u32 m0, s84, 8192
    s_add_u32 s86, s83, 262144
    buffer_load_dwordx4 v7, s[44:47], s86 offen lds
    s_add_u32 m0, s84, 12288
    s_add_u32 s86, s83, 393216
    buffer_load_dwordx4 v7, s[44:47], s86 offen lds
    s_add_u32 s83, s83, 524288
    s_add_u32 s87, s9, s14
    s_and_b32 s87, s87, 3
    s_mul_i32 s87, s87, 3
    s_lshr_b32 s88, s9, 2
    s_add_u32 s87, s87, s88
    s_mul_i32 s87, s87, 20480
    s_add_u32 s82, s16, s87
    s_add_u32 s9, s9, 1
    s_add_u32 m0, s84, 16384
    s_add_u32 s86, s82, 0
    buffer_load_dwordx4 v6, s[48:51], s86 offen sc1 lds
    s_add_u32 m0, s84, 20480
    s_add_u32 s86, s82, 4096
    buffer_load_dwordx4 v6, s[48:51], s86 offen sc1 lds
    s_add_u32 m0, s84, 24576
    s_add_u32 s86, s82, 8192
    buffer_load_dwordx4 v6, s[48:51], s86 offen sc1 lds
    s_add_u32 m0, s84, 28672
    s_add_u32 s86, s82, 12288
    buffer_load_dwordx4 v6, s[48:51], s86 offen sc1 lds
    s_add_u32 m0, s84, 32768
    s_add_u32 s86, s82, 16384
    buffer_load_dwordx4 v6, s[48:51], s86 offen sc1 lds
    s_add_u32 s82, s82, 20480
    s_add_u32 s80, s80, 36864
    s_cmp_eq_u32 s80, 147456
    s_cselect_b32 s80, 0, s80
    s_waitcnt vmcnt(18)
    s_barrier
    s_cmp_lg_u32 s69, 0
    s_cbranch_scc1 Lw0_1025
    s_lshl_b32 s90, s70, 4
    s_add_u32 s90, s90, s71
    s_lshl_b32 s90, s90, 2
    s_add_u32 s90, s90, 6144
    s_atomic_swap s77, s[48:49], s90
Lw0_1025:
    s_lshl_b32 s84, s69, 10
    s_add_u32 s84, s84, s80
    s_add_u32 s87, s10, s14
    s_and_b32 s87, s87, 3
    s_mul_i32 s87, s87, 3
    s_lshr_b32 s88, s10, 2
    s_add_u32 s87, s87, s88
    s_mul_i32 s87, s87, 524288
    s_add_u32 s83, s17, s87
    s_add_u32 s10, s10, 1
    s_add_u32 m0, s84, 0
    s_add_u32 s86, s83, 0
    buffer_load_dwordx4 v7, s[44:47], s86 offen lds
    s_add_u32 m0, s84, 4096
    s_add_u32 s86, s83, 131072
    buffer_load_dwordx4 v7, s[44:47], s86 offen lds
    s_add_u32 m0, s84, 8192
    s_add_u32 s86, s83, 262144
    buffer_load_dwordx4 v7, s[44:47], s86 offen lds
    s_add_u32 m0, s84, 12288
    s_add_u32 s86, s83, 393216
    buffer_load_dwordx4 v7, s[44:47], s86 offen lds
    s_add_u32 s83, s83, 524288
    s_add_u32 s87, s9, s14
    s_and_b32 s87, s87, 3
    s_mul_i32 s87, s87, 3
    s_lshr_b32 s88, s9, 2
    s_add_u32 s87, s87, s88
    s_mul_i32 s87, s87, 20480
    s_add_u32 s82, s16, s87
    s_add_u32 s9, s9, 1
    s_add_u32 m0, s84, 16384
    s_add_u32 s86, s82, 0
    buffer_load_dwordx4 v6, s[48:51], s86 offen sc1 lds
    s_add_u32 m0, s84, 20480
    s_add_u32 s86, s82, 4096
    buffer_load_dwordx4 v6, s[48:51], s86 offen sc1 lds
    s_add_u32 m0, s84, 24576
    s_add_u32 s86, s82, 8192
    buffer_load_dwordx4 v6, s[48:51], s86 offen sc1 lds
    s_add_u32 m0, s84, 28672
    s_add_u32 s86, s82, 12288
    buffer_load_dwordx4 v6, s[48:51], s86 offen sc1 lds
    s_add_u32 m0, s84, 32768
    s_add_u32 s86, s82, 16384
    buffer_load_dwordx4 v6, s[48:51], s86 offen sc1 lds
    s_add_u32 s82, s82, 20480
    s_add_u32 s80, s80, 36864
    s_cmp_eq_u32 s80, 147456
    s_cselect_b32 s80, 0, s80
    s_lshl_b32 s87, s74, 6
    s_lshr_b32 s88, s69, 1
    s_lshl_b32 s89, s88, 5
    s_add_u32 s87, s87, s89
    s_mul_i32 s87, s87, 1280
    s_mul_i32 s89, s75, 160
    s_add_u32 s87, s87, s89
    s_mul_i32 s88, s88, 5120
    s_add_u32 s88, s88, 147456
    s_and_b32 s89, s69, 1
    s_cmp_lg_u32 s89, 0
    s_cbranch_scc1 Lsel_1026
    s_add_u32 m0, s88, 0
    s_nop 0
    buffer_load_dwordx4 v9, s[28:31], s87 offen lds
    s_add_u32 m0, s88, 1024
    s_nop 0
    buffer_load_dwordx4 v10, s[28:31], s87 offen lds
    s_add_u32 m0, s88, 2048
    s_nop 0
    buffer_load_dwordx4 v11, s[28:31], s87 offen lds
    s_nop 7
    s_branch Lsele_1027
Lsel_1026:
    s_add_u32 m0, s88, 3072
    s_nop 0
    buffer_load_dwordx4 v12, s[28:31], s87 offen lds
    s_add_u32 m0, s88, 4096
    s_nop 0
    buffer_load_dwordx4 v13, s[28:31], s87 offen lds
    s_add_u32 m0, s88, 4096
    s_nop 0
    buffer_load_dwordx4 v13, s[28:31], s87 offen lds
    s_nop 7
Lsele_1027:
    s_waitcnt vmcnt(21)
    s_barrier
    s_lshl_b32 s84, s69, 10
    s_add_u32 s84, s84, s80
    s_add_u32 s87, s10, s14
    s_and_b32 s87, s87, 3
    s_mul_i32 s87, s87, 3
    s_lshr_b32 s88, s10, 2
    s_add_u32 s87, s87, s88
    s_mul_i32 s87, s87, 524288
    s_add_u32 s83, s17, s87
    s_add_u32 s10, s10, 1
    s_add_u32 m0, s84, 0
    s_add_u32 s86, s83, 0
    buffer_load_dwordx4 v7, s[44:47], s86 offen lds
    s_add_u32 m0, s84, 4096
    s_add_u32 s86, s83, 131072
    buffer_load_dwordx4 v7, s[44:47], s86 offen lds
    s_add_u32 m0, s84, 8192
    s_add_u32 s86, s83, 262144
    buffer_load_dwordx4 v7, s[44:47], s86 offen lds
    s_add_u32 m0, s84, 12288
    s_add_u32 s86, s83, 393216
    buffer_load_dwordx4 v7, s[44:47], s86 offen lds
    s_add_u32 s83, s83, 524288
    s_add_u32 s87, s9, s14
    s_and_b32 s87, s87, 3
    s_mul_i32 s87, s87, 3
    s_lshr_b32 s88, s9, 2
    s_add_u32 s87, s87, s88
    s_mul_i32 s87, s87, 20480
    s_add_u32 s82, s16, s87
    s_add_u32 s9, s9, 1
    s_add_u32 m0, s84, 16384
    s_add_u32 s86, s82, 0
    buffer_load_dwordx4 v6, s[48:51], s86 offen sc1 lds
    s_add_u32 m0, s84, 20480
    s_add_u32 s86, s82, 4096
    buffer_load_dwordx4 v6, s[48:51], s86 offen sc1 lds
    s_add_u32 m0, s84, 24576
    s_add_u32 s86, s82, 8192
    buffer_load_dwordx4 v6, s[48:51], s86 offen sc1 lds
    s_add_u32 m0, s84, 28672
    s_add_u32 s86, s82, 12288
    buffer_load_dwordx4 v6, s[48:51], s86 offen sc1 lds
    s_add_u32 m0, s84, 32768
    s_add_u32 s86, s82, 16384
    buffer_load_dwordx4 v6, s[48:51], s86 offen sc1 lds
    s_add_u32 s82, s82, 20480
    s_add_u32 s80, s80, 36864
    s_cmp_eq_u32 s80, 147456
    s_cselect_b32 s80, 0, s80
    s_waitcnt vmcnt(21)
    s_barrier
    s_lshl_b32 s84, s69, 10
    s_add_u32 s84, s84, s80
    s_add_u32 s87, s10, s14
    s_and_b32 s87, s87, 3
    s_mul_i32 s87, s87, 3
    s_lshr_b32 s88, s10, 2
    s_add_u32 s87, s87, s88
    s_mul_i32 s87, s87, 524288
    s_add_u32 s83, s17, s87
    s_add_u32 s10, s10, 1
    s_add_u32 m0, s84, 0
    s_add_u32 s86, s83, 0
    buffer_load_dwordx4 v7, s[44:47], s86 offen lds
    s_add_u32 m0, s84, 4096
    s_add_u32 s86, s83, 131072
    buffer_load_dwordx4 v7, s[44:47], s86 offen lds
    s_add_u32 m0, s84, 8192
    s_add_u32 s86, s83, 262144
    buffer_load_dwordx4 v7, s[44:47], s86 offen lds
    s_add_u32 m0, s84, 12288
    s_add_u32 s86, s83, 393216
    buffer_load_dwordx4 v7, s[44:47], s86 offen lds
    s_add_u32 s83, s83, 524288
    s_add_u32 s87, s9, s14
    s_and_b32 s87, s87, 3
    s_mul_i32 s87, s87, 3
    s_lshr_b32 s88, s9, 2
    s_add_u32 s87, s87, s88
    s_mul_i32 s87, s87, 20480
    s_add_u32 s82, s16, s87
    s_add_u32 s9, s9, 1
    s_add_u32 m0, s84, 16384
    s_add_u32 s86, s82, 0
    buffer_load_dwordx4 v6, s[48:51], s86 offen sc1 lds
    s_add_u32 m0, s84, 20480
    s_add_u32 s86, s82, 4096
    buffer_load_dwordx4 v6, s[48:51], s86 offen sc1 lds
    s_add_u32 m0, s84, 24576
    s_add_u32 s86, s82, 8192
    buffer_load_dwordx4 v6, s[48:51], s86 offen sc1 lds
    s_add_u32 m0, s84, 28672
    s_add_u32 s86, s82, 12288
    buffer_load_dwordx4 v6, s[48:51], s86 offen sc1 lds
    s_add_u32 m0, s84, 32768
    s_add_u32 s86, s82, 16384
    buffer_load_dwordx4 v6, s[48:51], s86 offen sc1 lds
    s_add_u32 s82, s82, 20480
    s_add_u32 s80, s80, 36864
    s_cmp_eq_u32 s80, 147456
    s_cselect_b32 s80, 0, s80
    s_waitcnt vmcnt(21)
    s_barrier
    buffer_load_dword v24, v17, s[48:51], 0 offen sc1
    s_lshl_b32 s84, s69, 10
    s_add_u32 s84, s84, s80
    s_add_u32 s87, s10, s14
    s_and_b32 s87, s87, 3
    s_mul_i32 s87, s87, 3
    s_lshr_b32 s88, s10, 2
    s_add_u32 s87, s87, s88
    s_mul_i32 s87, s87, 524288
    s_add_u32 s83, s17, s87
    s_add_u32 s10, s10, 1
    s_add_u32 m0, s84, 0
    s_add_u32 s86, s83, 0
    buffer_load_dwordx4 v7, s[44:47], s86 offen lds
    s_add_u32 m0, s84, 4096
    s_add_u32 s86, s83, 131072
    buffer_load_dwordx4 v7, s[44:47], s86 offen lds
    s_add_u32 m0, s84, 8192
    s_add_u32 s86, s83, 262144
    buffer_load_dwordx4 v7, s[44:47], s86 offen lds
    s_add_u32 m0, s84, 12288
    s_add_u32 s86, s83, 393216
    buffer_load_dwordx4 v7, s[44:47], s86 offen lds
    s_add_u32 s83, s83, 524288
    s_add_u32 s87, s9, s14
    s_and_b32 s87, s87, 3
    s_mul_i32 s87, s87, 3
    s_lshr_b32 s88, s9, 2
    s_add_u32 s87, s87, s88
    s_mul_i32 s87, s87, 20480
    s_add_u32 s82, s16, s87
    s_add_u32 s9, s9, 1
    s_add_u32 m0, s84, 16384
    s_add_u32 s86, s82, 0
    buffer_load_dwordx4 v6, s[48:51], s86 offen sc1 lds
    s_add_u32 m0, s84, 20480
    s_add_u32 s86, s82, 4096
    buffer_load_dwordx4 v6, s[48:51], s86 offen sc1 lds
    s_add_u32 m0, s84, 24576
    s_add_u32 s86, s82, 8192
    buffer_load_dwordx4 v6, s[48:51], s86 offen sc1 lds
    s_add_u32 m0, s84, 28672
    s_add_u32 s86, s82, 12288
    buffer_load_dwordx4 v6, s[48:51], s86 offen sc1 lds
    s_add_u32 m0, s84, 32768
    s_add_u32 s86, s82, 16384
    buffer_load_dwordx4 v6, s[48:51], s86 offen sc1 lds
    s_add_u32 s82, s82, 20480
    s_add_u32 s80, s80, 36864
    s_cmp_eq_u32 s80, 147456
    s_cselect_b32 s80, 0, s80
    s_waitcnt vmcnt(19)
    s_barrier
    s_lshl_b32 s84, s69, 10
    s_add_u32 s84, s84, s80
    s_add_u32 s87, s10, s14
    s_and_b32 s87, s87, 3
    s_mul_i32 s87, s87, 3
    s_lshr_b32 s88, s10, 2
    s_add_u32 s87, s87, s88
    s_mul_i32 s87, s87, 524288
    s_add_u32 s83, s17, s87
    s_add_u32 s10, s10, 1
    s_add_u32 m0, s84, 0
    s_add_u32 s86, s83, 0
    buffer_load_dwordx4 v7, s[44:47], s86 offen lds
    s_add_u32 m0, s84, 4096
    s_add_u32 s86, s83, 131072
    buffer_load_dwordx4 v7, s[44:47], s86 offen lds
    s_add_u32 m0, s84, 8192
    s_add_u32 s86, s83, 262144
    buffer_load_dwordx4 v7, s[44:47], s86 offen lds
    s_add_u32 m0, s84, 12288
    s_add_u32 s86, s83, 393216
    buffer_load_dwordx4 v7, s[44:47], s86 offen lds
    s_add_u32 s83, s83, 524288
    s_add_u32 s87, s9, s14
    s_and_b32 s87, s87, 3
    s_mul_i32 s87, s87, 3
    s_lshr_b32 s88, s9, 2
    s_add_u32 s87, s87, s88
    s_mul_i32 s87, s87, 20480
    s_add_u32 s82, s16, s87
    s_add_u32 s9, s9, 1
    s_add_u32 m0, s84, 16384
    s_add_u32 s86, s82, 0
    buffer_load_dwordx4 v6, s[48:51], s86 offen sc1 lds
    s_add_u32 m0, s84, 20480
    s_add_u32 s86, s82, 4096
    buffer_load_dwordx4 v6, s[48:51], s86 offen sc1 lds
    s_add_u32 m0, s84, 24576
    s_add_u32 s86, s82, 8192
    buffer_load_dwordx4 v6, s[48:51], s86 offen sc1 lds
    s_add_u32 m0, s84, 28672
    s_add_u32 s86, s82, 12288
    buffer_load_dwordx4 v6, s[48:51], s86 offen sc1 lds
    s_add_u32 m0, s84, 32768
    s_add_u32 s86, s82, 16384
    buffer_load_dwordx4 v6, s[48:51], s86 offen sc1 lds
    s_add_u32 s82, s82, 20480
    s_add_u32 s80, s80, 36864
    s_cmp_eq_u32 s80, 147456
    s_cselect_b32 s80, 0, s80
    s_waitcnt vmcnt(19)
    s_barrier
    s_lshl_b32 s84, s69, 10
    s_add_u32 s84, s84, s80
    s_add_u32 s87, s10, s14
    s_and_b32 s87, s87, 3
    s_mul_i32 s87, s87, 3
    s_lshr_b32 s88, s10, 2
    s_add_u32 s87, s87, s88
    s_mul_i32 s87, s87, 524288
    s_add_u32 s83, s17, s87
    s_add_u32 s10, s10, 1
    s_add_u32 m0, s84, 0
    s_add_u32 s86, s83, 0
    buffer_load_dwordx4 v7, s[44:47], s86 offen lds
    s_add_u32 m0, s84, 4096
    s_add_u32 s86, s83, 131072
    buffer_load_dwordx4 v7, s[44:47], s86 offen lds
    s_add_u32 m0, s84, 8192
    s_add_u32 s86, s83, 262144
    buffer_load_dwordx4 v7, s[44:47], s86 offen lds
    s_add_u32 m0, s84, 12288
    s_add_u32 s86, s83, 393216
    buffer_load_dwordx4 v7, s[44:47], s86 offen lds
    s_add_u32 s83, s83, 524288
    s_add_u32 s87, s9, s14
    s_and_b32 s87, s87, 3
    s_mul_i32 s87, s87, 3
    s_lshr_b32 s88, s9, 2
    s_add_u32 s87, s87, s88
    s_mul_i32 s87, s87, 20480
    s_add_u32 s82, s16, s87
    s_add_u32 s9, s9, 1
    s_add_u32 m0, s84, 16384
    s_add_u32 s86, s82, 0
    buffer_load_dwordx4 v6, s[48:51], s86 offen sc1 lds
    s_add_u32 m0, s84, 20480
    s_add_u32 s86, s82, 4096
    buffer_load_dwordx4 v6, s[48:51], s86 offen sc1 lds
    s_add_u32 m0, s84, 24576
    s_add_u32 s86, s82, 8192
    buffer_load_dwordx4 v6, s[48:51], s86 offen sc1 lds
    s_add_u32 m0, s84, 28672
    s_add_u32 s86, s82, 12288
    buffer_load_dwordx4 v6, s[48:51], s86 offen sc1 lds
    s_add_u32 m0, s84, 32768
    s_add_u32 s86, s82, 16384
    buffer_load_dwordx4 v6, s[48:51], s86 offen sc1 lds
    s_add_u32 s82, s82, 20480
    s_add_u32 s80, s80, 36864
    s_cmp_eq_u32 s80, 147456
    s_cselect_b32 s80, 0, s80
    s_waitcnt vmcnt(18)
    s_cmp_lg_u32 s69, 0
    s_cbranch_scc1 Lw0_1028
    v_cmp_eq_u32 s[86:87], s77, v24
    s_nop 3
    s_cmp_eq_u64 s[86:87], exec
    s_cbranch_scc1 Lpok_1029
    s_mov_b32 s85, 100000
Lspin_1030:
    s_sleep 2
    buffer_load_dword v24, v17, s[48:51], 0 offen sc1
    s_waitcnt vmcnt(0)
    v_cmp_eq_u32 s[86:87], s77, v24
    s_nop 3
    s_cmp_eq_u64 s[86:87], exec
    s_cbranch_scc1 Lpok_1029
    s_sub_u32 s85, s85, 1
    s_cmp_lg_u32 s85, 0
    s_cbranch_scc1 Lspin_1030
Lpok_1029:
Lw0_1028:
    s_barrier
    s_lshl_b32 s83, s74, 6
    s_lshl_b32 s86, s69, 2
    s_add_u32 s83, s83, s86
    s_mul_i32 s83, s83, 1280
    s_add_u32 s83, s83, 12845056
    s_mul_i32 s82, s69, 40960
    s_mul_i32 s86, s75, 160
    s_add_u32 s82, s82, s86
    s_mov_b32 s9, s15
    s_mul_i32 s86, s15, 163840
    s_add_u32 s82, s82, s86
    s_lshl_b32 s86, s15, 8
    s_add_u32 s83, s83, s86
    s_lshl_b32 s84, s69, 10
    s_add_u32 s84, s84, s80
    s_add_u32 m0, s84, 0
    s_add_u32 s86, s83, 0
    buffer_load_dwordx4 v8, s[48:51], s86 offen sc1 lds
    s_add_u32 m0, s84, 4096
    s_add_u32 s86, s83, 20480
    buffer_load_dwordx4 v8, s[48:51], s86 offen sc1 lds
    s_add_u32 m0, s84, 8192
    s_add_u32 s86, s83, 40960
    buffer_load_dwordx4 v8, s[48:51], s86 offen sc1 lds
    s_add_u32 m0, s84, 12288
    s_add_u32 s86, s83, 61440
    buffer_load_dwordx4 v8, s[48:51], s86 offen sc1 lds
    s_lshl_b32 s87, s69, 12
    s_add_u32 s84, s84, s87
    s_add_u32 m0, s84, 16384
    s_add_u32 s86, s82, 0
    buffer_load_dwordx4 v9, s[36:39], s86 offen lds
    s_add_u32 m0, s84, 17408
    s_add_u32 s86, s82, 0
    buffer_load_dwordx4 v10, s[36:39], s86 offen lds
    s_add_u32 m0, s84, 18432
    s_add_u32 s86, s82, 0
    buffer_load_dwordx4 v11, s[36:39], s86 offen lds
    s_add_u32 m0, s84, 19456
    s_add_u32 s86, s82, 0
    buffer_load_dwordx4 v12, s[36:39], s86 offen lds
    s_add_u32 m0, s84, 20480
    s_add_u32 s86, s82, 0
    buffer_load_dwordx4 v13, s[36:39], s86 offen lds
    s_add_u32 s82, s82, 163840
    s_add_u32 s83, s83, 256
    s_add_u32 s80, s80, 36864
    s_cmp_eq_u32 s80, 147456
    s_cselect_b32 s80, 0, s80
    s_add_u32 s9, s9, 1
    s_cmp_eq_u32 s9, 5
    s_cselect_b32 s9, 0, s9
    s_cselect_b32 s87, 819200, 0
    s_cselect_b32 s88, 1280, 0
    s_sub_u32 s82, s82, s87
    s_sub_u32 s83, s83, s88
    s_mov_b32 s81, 4
Lloop_1031:
    s_waitcnt vmcnt(18)
    s_barrier
    s_lshl_b32 s84, s69, 10
    s_add_u32 s84, s84, s80
    s_add_u32 m0, s84, 0
    s_add_u32 s86, s83, 0
    buffer_load_dwordx4 v8, s[48:51], s86 offen sc1 lds
    s_add_u32 m0, s84, 4096
    s_add_u32 s86, s83, 20480
    buffer_load_dwordx4 v8, s[48:51], s86 offen sc1 lds
    s_add_u32 m0, s84, 8192
    s_add_u32 s86, s83, 40960
    buffer_load_dwordx4 v8, s[48:51], s86 offen sc1 lds
    s_add_u32 m0, s84, 12288
    s_add_u32 s86, s83, 61440
    buffer_load_dwordx4 v8, s[48:51], s86 offen sc1 lds
    s_lshl_b32 s87, s69, 12
    s_add_u32 s84, s84, s87
    s_add_u32 m0, s84, 16384
    s_add_u32 s86, s82, 0
    buffer_load_dwordx4 v9, s[36:39], s86 offen lds
    s_add_u32 m0, s84, 17408
    s_add_u32 s86, s82, 0
    buffer_load_dwordx4 v10, s[36:39], s86 offen lds
    s_add_u32 m0, s84, 18432
    s_add_u32 s86, s82, 0
    buffer_load_dwordx4 v11, s[36:39], s86 offen lds
    s_add_u32 m0, s84, 19456
    s_add_u32 s86, s82, 0
    buffer_load_dwordx4 v12, s[36:39], s86 offen lds
    s_add_u32 m0, s84, 20480
    s_add_u32 s86, s82, 0
    buffer_load_dwordx4 v13, s[36:39], s86 offen lds
    s_add_u32 s82, s82, 163840
    s_add_u32 s83, s83, 256
    s_add_u32 s80, s80, 36864
    s_cmp_eq_u32 s80, 147456
    s_cselect_b32 s80, 0, s80
    s_add_u32 s9, s9, 1
    s_cmp_eq_u32 s9, 5
    s_cselect_b32 s9, 0, s9
    s_cselect_b32 s87, 819200, 0
    s_cselect_b32 s88, 1280, 0
    s_sub_u32 s82, s82, s87
    s_sub_u32 s83, s83, s88
    s_sub_u32 s81, s81, 1
    s_cmp_lg_u32 s81, 0
    s_cbranch_scc1 Lloop_1031
    s_waitcnt vmcnt(18)
    s_barrier
    s_waitcnt vmcnt(9)
    s_barrier
    s_waitcnt vmcnt(0)
    s_barrier
    s_barrier
    s_endpgm
parallel_sum__sliding_block__mixer_token_mlp__prompt_kernel_compute:
    s_waitcnt lgkmcnt(0)
    v_mov_b32 v224, 2146435072
    v_mov_b32 v225, 2146435072
    s_cmp_eq_u32 s18, 0
    s_cbranch_scc1 Lnold_1032
    s_mul_i32 s86, s19, 8
    s_mul_i32 s87, s69, 2
    s_add_u32 s86, s86, s87
    v_lshrrev_b32 v101, 5, v0
    v_add_u32 v101, s86, v101
    v_and_b32 v102, 31, v0
    v_lshlrev_b32 v102, 3, v102
    v_mul_u32_u24 v100, 1280, v101
    v_add_u32 v100, v100, v102
    buffer_load_dwordx2 v[64:65], v100, s[28:31], 0 offen offset:0
    buffer_load_dwordx2 v[66:67], v100, s[28:31], 0 offen offset:256
    buffer_load_dwordx2 v[68:69], v100, s[28:31], 0 offen offset:512
    buffer_load_dwordx2 v[70:71], v100, s[28:31], 0 offen offset:768
    buffer_load_dwordx2 v[72:73], v100, s[28:31], 0 offen offset:1024
Lnold_1032:
    v_mov_b32 v1, 158208
    v_mov_b32 v2, 0
    v_mov_b32 v3, 0
    ds_write_b64 v1, v[2:3]
    v_and_b32 v190, 15, v0
    v_lshrrev_b32 v191, 2, v190
    v_lshrrev_b32 v192, 5, v0
    v_lshl_add_u32 v193, v192, 3, v191
    s_lshl_b32 s86, s94, 6
    v_add_u32 v193, s86, v193
    v_lshlrev_b32 v193, 7, v193
    v_and_b32 v194, 1, v0
    v_lshl_add_u32 v193, v194, 3, v193
    v_bfe_u32 v194, v0, 4, 1
    v_lshlrev_b32 v194, 1, v194
    v_bfe_u32 v190, v0, 1, 1
    v_or_b32 v194, v194, v190
    v_bfe_u32 v191, v0, 3, 1
    v_lshlrev_b32 v191, 2, v191
    v_or_b32 v190, 0, v194
    v_xor_b32 v190, v190, v191
    v_lshl_add_u32 v45, v190, 4, v193
    v_or_b32 v190, 4, v194
    v_xor_b32 v190, v190, v191
    v_lshl_add_u32 v46, v190, 4, v193
    s_lshl_b32 s86, s95, 2
    v_or_b32 v190, s86, v194
    v_xor_b32 v190, v190, v191
    v_lshl_add_u32 v47, v190, 4, v193
    v_add_u32 v47, 16384, v47
    s_cmp_eq_u32 s94, 0
    s_cbranch_scc1 Lmsw_1033
    v_mov_b32 v1, v45
    v_mov_b32 v45, v46
    v_mov_b32 v46, v1
Lmsw_1033:
    v_and_b32 v206, 15, v0
    v_lshrrev_b32 v207, 2, v206
    v_lshrrev_b32 v208, 4, v0
    v_lshl_add_u32 v209, v208, 2, v207
    s_lshl_b32 s86, s94, 6
    v_add_u32 v209, s86, v209
    v_mul_u32_u24 v38, 160, v209
    v_and_b32 v210, 3, v0
    v_lshl_add_u32 v38, v210, 3, v38
    v_add_u32 v38, 16384, v38
    v_lshlrev_b32 v209, 7, v209
    v_and_b32 v210, 1, v0
    v_lshl_add_u32 v209, v210, 3, v209
    v_bfe_u32 v210, v0, 1, 1
    s_lshl_b32 s86, s95, 2
    v_or_b32 v210, s86, v210
    v_bfe_u32 v206, v0, 4, 1
    v_lshlrev_b32 v206, 1, v206
    v_bfe_u32 v207, v0, 3, 1
    v_or_b32 v206, v206, v207
    v_lshlrev_b32 v206, 1, v206
    v_or_b32 v207, 0, v210
    v_xor_b32 v207, v207, v206
    v_lshl_add_u32 v39, v207, 4, v209
    v_or_b32 v207, 2, v210
    v_xor_b32 v207, v207, v206
    v_lshl_add_u32 v40, v207, 4, v209
    v_and_b32 v206, 15, v0
    s_lshl_b32 s86, s95, 5
    v_add_u32 v207, s86, v206
    v_lshlrev_b32 v207, 8, v207
    v_bfe_u32 v208, v0, 4, 1
    v_lshl_add_u32 v207, v208, 3, v207
    v_lshrrev_b32 v208, 5, v0
    s_lshl_b32 s86, s94, 3
    v_add_u32 v208, s86, v208
    v_add_u32 v209, 0, v208
    v_xor_b32 v209, v209, v206
    v_lshl_add_u32 v41, v209, 4, v207
    v_add_u32 v209, 2, v208
    v_xor_b32 v209, v209, v206
    v_lshl_add_u32 v42, v209, 4, v207
    v_add_u32 v209, 4, v208
    v_xor_b32 v209, v209, v206
    v_lshl_add_u32 v43, v209, 4, v207
    v_add_u32 v209, 6, v208
    v_xor_b32 v209, v209, v206
    v_lshl_add_u32 v44, v209, 4, v207
    v_and_b32 v192, 31, v0
    s_lshl_b32 s86, s69, 5
    v_add_u32 v193, s86, v192
    v_mul_u32_u24 v193, 168, v193
    v_add_u32 v35, 73728, v193
    v_lshrrev_b32 v194, 5, v0
    v_lshl_add_u32 v34, v194, 4, v35
    v_and_b32 v192, 15, v0
    v_lshrrev_b32 v193, 2, v192
    v_lshl_add_u32 v193, v194, 2, v193
    v_add_u32 v193, s86, v193
    v_mul_u32_u24 v193, 168, v193
    v_add_u32 v193, 73728, v193
    v_and_b32 v195, 3, v0
    v_lshlrev_b32 v196, 3, v195
    v_add_u32 v196, 80, v196
    v_bfe_u32 v197, v0, 4, 1
    v_cmp_eq_u32 vcc, 0, v195
    v_mov_b32 v198, 160
    v_mov_b32 v199, 112
    v_cndmask_b32 v199, v198, v199, vcc
    v_cmp_eq_u32 vcc, 0, v197
    s_nop 1
    v_cndmask_b32 v199, v199, v196, vcc
    v_add_u32 v36, v193, v199
    v_add_u32 v196, 40, v196
    v_cmp_eq_u32 vcc, 0, v195
    v_mov_b32 v199, 152
    s_nop 0
    v_cndmask_b32 v199, v198, v199, vcc
    v_cmp_eq_u32 vcc, 0, v197
    s_nop 1
    v_cndmask_b32 v199, v199, v196, vcc
    v_add_u32 v37, v193, v199
    v_and_b32 v192, 31, v0
    v_lshlrev_b32 v193, 2, v194
    v_sub_u32 v192, v192, v193
    v_mov_b32 v195, 0xf149f2ca
    v_cmp_gt_i32 vcc, 0, v192
    s_nop 1
    v_cndmask_b32 v2, v195, 0, vcc
    v_cndmask_b32 v18, 0, v195, vcc
    v_cmp_gt_i32 vcc, 1, v192
    s_nop 1
    v_cndmask_b32 v3, v195, 0, vcc
    v_cndmask_b32 v19, 0, v195, vcc
    v_cmp_gt_i32 vcc, 2, v192
    s_nop 1
    v_cndmask_b32 v4, v195, 0, vcc
    v_cndmask_b32 v20, 0, v195, vcc
    v_cmp_gt_i32 vcc, 3, v192
    s_nop 1
    v_cndmask_b32 v5, v195, 0, vcc
    v_cndmask_b32 v21, 0, v195, vcc
    v_cmp_gt_i32 vcc, 8, v192
    s_nop 1
    v_cndmask_b32 v6, v195, 0, vcc
    v_cndmask_b32 v22, 0, v195, vcc
    v_cmp_gt_i32 vcc, 9, v192
    s_nop 1
    v_cndmask_b32 v7, v195, 0, vcc
    v_cndmask_b32 v23, 0, v195, vcc
    v_cmp_gt_i32 vcc, 10, v192
    s_nop 1
    v_cndmask_b32 v8, v195, 0, vcc
    v_cndmask_b32 v24, 0, v195, vcc
    v_cmp_gt_i32 vcc, 11, v192
    s_nop 1
    v_cndmask_b32 v9, v195, 0, vcc
    v_cndmask_b32 v25, 0, v195, vcc
    v_cmp_gt_i32 vcc, 16, v192
    s_nop 1
    v_cndmask_b32 v10, v195, 0, vcc
    v_cndmask_b32 v26, 0, v195, vcc
    v_cmp_gt_i32 vcc, 17, v192
    s_nop 1
    v_cndmask_b32 v11, v195, 0, vcc
    v_cndmask_b32 v27, 0, v195, vcc
    v_cmp_gt_i32 vcc, 18, v192
    s_nop 1
    v_cndmask_b32 v12, v195, 0, vcc
    v_cndmask_b32 v28, 0, v195, vcc
    v_cmp_gt_i32 vcc, 19, v192
    s_nop 1
    v_cndmask_b32 v13, v195, 0, vcc
    v_cndmask_b32 v29, 0, v195, vcc
    v_cmp_gt_i32 vcc, 24, v192
    s_nop 1
    v_cndmask_b32 v14, v195, 0, vcc
    v_cndmask_b32 v30, 0, v195, vcc
    v_cmp_gt_i32 vcc, 25, v192
    s_nop 1
    v_cndmask_b32 v15, v195, 0, vcc
    v_cndmask_b32 v31, 0, v195, vcc
    v_cmp_gt_i32 vcc, 26, v192
    s_nop 1
    v_cndmask_b32 v16, v195, 0, vcc
    v_cndmask_b32 v32, 0, v195, vcc
    v_cmp_gt_i32 vcc, 27, v192
    s_nop 1
    v_cndmask_b32 v17, v195, 0, vcc
    v_cndmask_b32 v33, 0, v195, vcc
    s_mov_b32 s80, 0
    v_and_b32 v180, 15, v0
    v_lshrrev_b32 v181, 2, v180
    v_lshrrev_b32 v182, 5, v0
    v_lshl_add_u32 v183, v182, 3, v181
    v_lshlrev_b32 v183, 8, v183
    v_and_b32 v184, 1, v0
    v_lshl_add_u32 v183, v184, 3, v183
    v_add_u32 v183, 16384, v183
    v_bfe_u32 v184, v0, 4, 1
    v_lshlrev_b32 v184, 1, v184
    v_bfe_u32 v180, v0, 1, 1
    v_or_b32 v184, v184, v180
    s_lshl_b32 s86, s94, 3
    v_or_b32 v184, s86, v184
    v_lshlrev_b32 v181, 2, v181
    v_or_b32 v180, 0, v184
    v_xor_b32 v180, v180, v181
    v_lshl_add_u32 v200, v180, 4, v183
    v_or_b32 v180, 4, v184
    v_xor_b32 v180, v180, v181
    v_lshl_add_u32 v201, v180, 4, v183
    v_and_b32 v180, 31, v0
    v_bfe_u32 v181, v0, 1, 3
    v_lshrrev_b32 v182, 5, v0
    v_bfe_u32 v183, v0, 4, 1
    v_lshlrev_b32 v183, 3, v183
    v_bfe_u32 v181, v180, 1, 3
    v_xor_b32 v181, v181, v182
    s_lshl_b32 s86, s95, 6
    v_add_u32 v180, s86, v180
    v_lshlrev_b32 v180, 7, v180
    v_xor_b32 v183, 0, v181
    v_lshl_add_u32 v202, v183, 4, v180
    v_xor_b32 v183, 2, v181
    v_lshl_add_u32 v203, v183, 4, v180
    v_xor_b32 v183, 4, v181
    v_lshl_add_u32 v204, v183, 4, v180
    v_xor_b32 v183, 6, v181
    v_lshl_add_u32 v205, v183, 4, v180
    v_and_b32 v180, 15, v0
    v_bfe_u32 v181, v0, 4, 1
    v_cmp_eq_u32 vcc, v180, v181
    v_mov_b32 v182, 0x3f803f80
    s_nop 0
    v_cndmask_b32 v132, 0, v182, vcc
    v_mov_b32 v133, v132
    v_mov_b32 v134, v132
    v_mov_b32 v135, v132
    s_cmp_eq_u32 s18, 0
    s_cbranch_scc1 Lnolc_1034
    s_mov_b32 s89, 0xffff0000
    s_waitcnt vmcnt(0)
    v_lshlrev_b32 v76, 16, v64
    v_and_b32 v77, s89, v64
    v_lshlrev_b32 v78, 16, v65
    v_and_b32 v79, s89, v65
    v_lshlrev_b32 v80, 16, v66
    v_and_b32 v81, s89, v66
    v_lshlrev_b32 v82, 16, v67
    v_and_b32 v83, s89, v67
    v_lshlrev_b32 v84, 16, v68
    v_and_b32 v85, s89, v68
    v_lshlrev_b32 v86, 16, v69
    v_and_b32 v87, s89, v69
    v_lshlrev_b32 v88, 16, v70
    v_and_b32 v89, s89, v70
    v_lshlrev_b32 v90, 16, v71
    v_and_b32 v91, s89, v71
    v_lshlrev_b32 v92, 16, v72
    v_and_b32 v93, s89, v72
    v_lshlrev_b32 v94, 16, v73
    v_and_b32 v95, s89, v73
    v_pk_add_f32 v[104:105], v[76:77], v[78:79]
    v_pk_mul_f32 v[106:107], v[76:77], v[76:77]
    v_pk_fma_f32 v[106:107], v[78:79], v[78:79], v[106:107]
    v_pk_add_f32 v[104:105], v[104:105], v[80:81]
    v_pk_fma_f32 v[106:107], v[80:81], v[80:81], v[106:107]
    v_pk_add_f32 v[104:105], v[104:105], v[82:83]
    v_pk_fma_f32 v[106:107], v[82:83], v[82:83], v[106:107]
    v_pk_add_f32 v[104:105], v[104:105], v[84:85]
    v_pk_fma_f32 v[106:107], v[84:85], v[84:85], v[106:107]
    v_pk_add_f32 v[104:105], v[104:105], v[86:87]
    v_pk_fma_f32 v[106:107], v[86:87], v[86:87], v[106:107]
    v_pk_add_f32 v[104:105], v[104:105], v[88:89]
    v_pk_fma_f32 v[106:107], v[88:89], v[88:89], v[106:107]
    v_pk_add_f32 v[104:105], v[104:105], v[90:91]
    v_pk_fma_f32 v[106:107], v[90:91], v[90:91], v[106:107]
    v_pk_add_f32 v[104:105], v[104:105], v[92:93]
    v_pk_fma_f32 v[106:107], v[92:93], v[92:93], v[106:107]
    v_pk_add_f32 v[104:105], v[104:105], v[94:95]
    v_pk_fma_f32 v[106:107], v[94:95], v[94:95], v[106:107]
    v_add_f32 v104, v104, v105
    v_add_f32 v106, v106, v107
    v_nop
    v_add_f32_dpp v104, v104, v104 row_ror:8 row_mask:0xf bank_mask:0xf
    v_add_f32_dpp v106, v106, v106 row_ror:8 row_mask:0xf bank_mask:0xf
    v_nop
    v_add_f32_dpp v104, v104, v104 row_ror:4 row_mask:0xf bank_mask:0xf
    v_add_f32_dpp v106, v106, v106 row_ror:4 row_mask:0xf bank_mask:0xf
    v_nop
    v_add_f32_dpp v104, v104, v104 row_ror:2 row_mask:0xf bank_mask:0xf
    v_add_f32_dpp v106, v106, v106 row_ror:2 row_mask:0xf bank_mask:0xf
    v_nop
    v_add_f32_dpp v104, v104, v104 row_ror:1 row_mask:0xf bank_mask:0xf
    v_add_f32_dpp v106, v106, v106 row_ror:1 row_mask:0xf bank_mask:0xf
    v_nop
    v_mov_b32 v108, v104
    v_mov_b32 v109, v104
    v_mov_b32 v110, v106
    v_mov_b32 v111, v106
    v_permlane16_swap_b32 v108, v109
    s_nop 0
    v_permlane16_swap_b32 v110, v111
    v_add_f32 v104, v108, v109
    v_add_f32 v106, v110, v111
    v_mul_f32 v104, 0x3acccccd, v104
    v_mov_b32 v108, 0x3727c5ac
    v_fmac_f32 v108, 0x3acccccd, v106
    v_fma_f32 v108, -v104, v104, v108
    v_max_f32 v108, 0x3727c5ac, v108
    v_rsq_f32 v112, v108
    s_nop 0
    v_mul_f32 v113, v104, v112
    v_mov_b32 v222, v104
    v_mov_b32 v223, v112
    v_pk_fma_f32 v[76:77], v[76:77], v[112:113], v[112:113] op_sel:[0,0,1] op_sel_hi:[1,0,1] neg_lo:[0,0,1] neg_hi:[0,0,1]
    v_pk_fma_f32 v[78:79], v[78:79], v[112:113], v[112:113] op_sel:[0,0,1] op_sel_hi:[1,0,1] neg_lo:[0,0,1] neg_hi:[0,0,1]
    v_pk_fma_f32 v[80:81], v[80:81], v[112:113], v[112:113] op_sel:[0,0,1] op_sel_hi:[1,0,1] neg_lo:[0,0,1] neg_hi:[0,0,1]
    v_pk_fma_f32 v[82:83], v[82:83], v[112:113], v[112:113] op_sel:[0,0,1] op_sel_hi:[1,0,1] neg_lo:[0,0,1] neg_hi:[0,0,1]
    v_pk_fma_f32 v[84:85], v[84:85], v[112:113], v[112:113] op_sel:[0,0,1] op_sel_hi:[1,0,1] neg_lo:[0,0,1] neg_hi:[0,0,1]
    v_pk_fma_f32 v[86:87], v[86:87], v[112:113], v[112:113] op_sel:[0,0,1] op_sel_hi:[1,0,1] neg_lo:[0,0,1] neg_hi:[0,0,1]
    v_pk_fma_f32 v[88:89], v[88:89], v[112:113], v[112:113] op_sel:[0,0,1] op_sel_hi:[1,0,1] neg_lo:[0,0,1] neg_hi:[0,0,1]
    v_pk_fma_f32 v[90:91], v[90:91], v[112:113], v[112:113] op_sel:[0,0,1] op_sel_hi:[1,0,1] neg_lo:[0,0,1] neg_hi:[0,0,1]
    v_pk_fma_f32 v[92:93], v[92:93], v[112:113], v[112:113] op_sel:[0,0,1] op_sel_hi:[1,0,1] neg_lo:[0,0,1] neg_hi:[0,0,1]
    v_pk_fma_f32 v[94:95], v[94:95], v[112:113], v[112:113] op_sel:[0,0,1] op_sel_hi:[1,0,1] neg_lo:[0,0,1] neg_hi:[0,0,1]
    v_cvt_pk_bf16_f32 v64, v76, v77
    v_cvt_pk_bf16_f32 v65, v78, v79
    v_cvt_pk_bf16_f32 v66, v80, v81
    v_cvt_pk_bf16_f32 v67, v82, v83
    v_cvt_pk_bf16_f32 v68, v84, v85
    v_cvt_pk_bf16_f32 v69, v86, v87
    v_cvt_pk_bf16_f32 v70, v88, v89
    v_cvt_pk_bf16_f32 v71, v90, v91
    v_cvt_pk_bf16_f32 v72, v92, v93
    v_cvt_pk_bf16_f32 v73, v94, v95
    v_lshlrev_b32 v76, 16, v64
    v_and_b32 v77, s89, v64
    v_lshlrev_b32 v78, 16, v65
    v_and_b32 v79, s89, v65
    v_lshlrev_b32 v80, 16, v66
    v_and_b32 v81, s89, v66
    v_lshlrev_b32 v82, 16, v67
    v_and_b32 v83, s89, v67
    v_lshlrev_b32 v84, 16, v68
    v_and_b32 v85, s89, v68
    v_lshlrev_b32 v86, 16, v69
    v_and_b32 v87, s89, v69
    v_lshlrev_b32 v88, 16, v70
    v_and_b32 v89, s89, v70
    v_lshlrev_b32 v90, 16, v71
    v_and_b32 v91, s89, v71
    v_lshlrev_b32 v92, 16, v72
    v_and_b32 v93, s89, v72
    v_lshlrev_b32 v94, 16, v73
    v_and_b32 v95, s89, v73
    v_pk_add_f32 v[104:105], v[76:77], v[78:79]
    v_pk_mul_f32 v[106:107], v[76:77], v[76:77]
    v_pk_fma_f32 v[106:107], v[78:79], v[78:79], v[106:107]
    v_pk_add_f32 v[104:105], v[104:105], v[80:81]
    v_pk_fma_f32 v[106:107], v[80:81], v[80:81], v[106:107]
    v_pk_add_f32 v[104:105], v[104:105], v[82:83]
    v_pk_fma_f32 v[106:107], v[82:83], v[82:83], v[106:107]
    v_pk_add_f32 v[104:105], v[104:105], v[84:85]
    v_pk_fma_f32 v[106:107], v[84:85], v[84:85], v[106:107]
    v_pk_add_f32 v[104:105], v[104:105], v[86:87]
    v_pk_fma_f32 v[106:107], v[86:87], v[86:87], v[106:107]
    v_pk_add_f32 v[104:105], v[104:105], v[88:89]
    v_pk_fma_f32 v[106:107], v[88:89], v[88:89], v[106:107]
    v_pk_add_f32 v[104:105], v[104:105], v[90:91]
    v_pk_fma_f32 v[106:107], v[90:91], v[90:91], v[106:107]
    v_pk_add_f32 v[104:105], v[104:105], v[92:93]
    v_pk_fma_f32 v[106:107], v[92:93], v[92:93], v[106:107]
    v_pk_add_f32 v[104:105], v[104:105], v[94:95]
    v_pk_fma_f32 v[106:107], v[94:95], v[94:95], v[106:107]
    v_add_f32 v104, v104, v105
    v_add_f32 v106, v106, v107
    v_nop
    v_add_f32_dpp v104, v104, v104 row_ror:8 row_mask:0xf bank_mask:0xf
    v_add_f32_dpp v106, v106, v106 row_ror:8 row_mask:0xf bank_mask:0xf
    v_nop
    v_add_f32_dpp v104, v104, v104 row_ror:4 row_mask:0xf bank_mask:0xf
    v_add_f32_dpp v106, v106, v106 row_ror:4 row_mask:0xf bank_mask:0xf
    v_nop
    v_add_f32_dpp v104, v104, v104 row_ror:2 row_mask:0xf bank_mask:0xf
    v_add_f32_dpp v106, v106, v106 row_ror:2 row_mask:0xf bank_mask:0xf
    v_nop
    v_add_f32_dpp v104, v104, v104 row_ror:1 row_mask:0xf bank_mask:0xf
    v_add_f32_dpp v106, v106, v106 row_ror:1 row_mask:0xf bank_mask:0xf
    v_nop
    v_mov_b32 v108, v104
    v_mov_b32 v109, v104
    v_mov_b32 v110, v106
    v_mov_b32 v111, v106
    v_permlane16_swap_b32 v108, v109
    s_nop 0
    v_permlane16_swap_b32 v110, v111
    v_add_f32 v104, v108, v109
    v_add_f32 v106, v110, v111
    v_mul_f32 v104, 0x3acccccd, v104
    v_mov_b32 v108, 0x3727c5ac
    v_fmac_f32 v108, 0x3acccccd, v106
    v_fma_f32 v108, -v104, v104, v108
    v_max_f32 v108, 0x3727c5ac, v108
    v_rsq_f32 v112, v108
    s_nop 0
    v_mul_f32 v113, v104, v112
    v_pk_fma_f32 v[76:77], v[76:77], v[112:113], v[112:113] op_sel:[0,0,1] op_sel_hi:[1,0,1] neg_lo:[0,0,1] neg_hi:[0,0,1]
    v_pk_fma_f32 v[78:79], v[78:79], v[112:113], v[112:113] op_sel:[0,0,1] op_sel_hi:[1,0,1] neg_lo:[0,0,1] neg_hi:[0,0,1]
    v_pk_fma_f32 v[80:81], v[80:81], v[112:113], v[112:113] op_sel:[0,0,1] op_sel_hi:[1,0,1] neg_lo:[0,0,1] neg_hi:[0,0,1]
    v_pk_fma_f32 v[82:83], v[82:83], v[112:113], v[112:113] op_sel:[0,0,1] op_sel_hi:[1,0,1] neg_lo:[0,0,1] neg_hi:[0,0,1]
    v_pk_fma_f32 v[84:85], v[84:85], v[112:113], v[112:113] op_sel:[0,0,1] op_sel_hi:[1,0,1] neg_lo:[0,0,1] neg_hi:[0,0,1]
    v_pk_fma_f32 v[86:87], v[86:87], v[112:113], v[112:113] op_sel:[0,0,1] op_sel_hi:[1,0,1] neg_lo:[0,0,1] neg_hi:[0,0,1]
    v_pk_fma_f32 v[88:89], v[88:89], v[112:113], v[112:113] op_sel:[0,0,1] op_sel_hi:[1,0,1] neg_lo:[0,0,1] neg_hi:[0,0,1]
    v_pk_fma_f32 v[90:91], v[90:91], v[112:113], v[112:113] op_sel:[0,0,1] op_sel_hi:[1,0,1] neg_lo:[0,0,1] neg_hi:[0,0,1]
    v_pk_fma_f32 v[92:93], v[92:93], v[112:113], v[112:113] op_sel:[0,0,1] op_sel_hi:[1,0,1] neg_lo:[0,0,1] neg_hi:[0,0,1]
    v_pk_fma_f32 v[94:95], v[94:95], v[112:113], v[112:113] op_sel:[0,0,1] op_sel_hi:[1,0,1] neg_lo:[0,0,1] neg_hi:[0,0,1]
    v_cvt_pk_bf16_f32 v212, v76, v77
    v_cvt_pk_bf16_f32 v213, v78, v79
    v_cvt_pk_bf16_f32 v214, v80, v81
    v_cvt_pk_bf16_f32 v215, v82, v83
    v_cvt_pk_bf16_f32 v216, v84, v85
    v_cvt_pk_bf16_f32 v217, v86, v87
    v_cvt_pk_bf16_f32 v218, v88, v89
    v_cvt_pk_bf16_f32 v219, v90, v91
    v_cvt_pk_bf16_f32 v220, v92, v93
    v_cvt_pk_bf16_f32 v221, v94, v95
    v_add_u32 v224, 65536, v100
    v_lshlrev_b32 v104, 3, v101
    v_add_u32 v104, 16384, v104
    v_and_b32 v102, 31, v0
    v_mov_b32 v103, 2146435072
    v_cmp_eq_u32 vcc, 0, v102
    s_nop 1
    v_cndmask_b32 v225, v103, v104, vcc
Lnolc_1034:
    s_waitcnt lgkmcnt(0)
    v_add_u32 v206, s80, v200
    v_add_u32 v207, s80, v201
    v_add_u32 v208, s80, v202
    v_add_u32 v209, s80, v203
    v_add_u32 v210, s80, v204
    v_add_u32 v211, s80, v205
    s_cmp_lg_u32 s95, 0
    s_cbranch_scc1 Lsel_1035
    s_barrier
    s_cmp_eq_u32 s18, 0
    s_cbranch_scc1 Lnoln_1037
    buffer_store_dwordx2 v[212:213], v224, s[48:51], 0 offen offset:0 sc1
    buffer_store_dwordx2 v[214:215], v224, s[48:51], 0 offen offset:256 sc1
    buffer_store_dwordx2 v[216:217], v224, s[48:51], 0 offen offset:512 sc1
    buffer_store_dwordx2 v[218:219], v224, s[48:51], 0 offen offset:768 sc1
    buffer_store_dwordx2 v[220:221], v224, s[48:51], 0 offen offset:1024 sc1
    buffer_store_dwordx2 v[222:223], v225, s[48:51], 0 offen sc1
Lnoln_1037:
    ds_read_b64_tr_b16 v[136:137], v206 offset:0
    ds_read_b64_tr_b16 v[138:139], v206 offset:1024
    ds_read_b64_tr_b16 v[140:141], v207 offset:0
    ds_read_b64_tr_b16 v[142:143], v207 offset:1024
    ds_read_b128 v[144:147], v208 offset:0
    ds_read_b128 v[148:151], v208 offset:4096
    ds_read_b64_tr_b16 v[152:153], v206 offset:4096
    ds_read_b64_tr_b16 v[154:155], v206 offset:5120
    ds_read_b64_tr_b16 v[156:157], v207 offset:4096
    ds_read_b64_tr_b16 v[158:159], v207 offset:5120
    ds_read_b128 v[160:163], v209 offset:0
    ds_read_b128 v[164:167], v209 offset:4096
    s_waitcnt lgkmcnt(6)
    v_mfma_f32_32x32x16_bf16 v[64:79], v[136:139], v[144:147], 0
    ds_read_b64_tr_b16 v[168:169], v206 offset:8192
    ds_read_b64_tr_b16 v[170:171], v206 offset:9216
    v_mfma_f32_32x32x16_bf16 v[80:95], v[136:139], v[148:151], 0
    ds_read_b64_tr_b16 v[172:173], v207 offset:8192
    v_mfma_f32_32x32x16_bf16 v[96:111], v[140:143], v[144:147], 0
    ds_read_b64_tr_b16 v[174:175], v207 offset:9216
    v_mfma_f32_32x32x16_bf16 v[112:127], v[140:143], v[148:151], 0
    ds_read_b128 v[176:179], v210 offset:0
    v_mfma_f32_16x16x32_bf16 v[128:131], v[136:139], v[132:135], 0
    ds_read_b128 v[180:183], v210 offset:4096
    s_waitcnt lgkmcnt(6)
    v_mfma_f32_32x32x16_bf16 v[64:79], v[152:155], v[160:163], v[64:79]
    ds_read_b64_tr_b16 v[184:185], v206 offset:12288
    ds_read_b64_tr_b16 v[186:187], v206 offset:13312
    v_mfma_f32_32x32x16_bf16 v[80:95], v[152:155], v[164:167], v[80:95]
    ds_read_b64_tr_b16 v[188:189], v207 offset:12288
    v_mfma_f32_32x32x16_bf16 v[96:111], v[156:159], v[160:163], v[96:111]
    ds_read_b64_tr_b16 v[190:191], v207 offset:13312
    v_mfma_f32_32x32x16_bf16 v[112:127], v[156:159], v[164:167], v[112:127]
    ds_read_b128 v[192:195], v211 offset:0
    v_mfma_f32_16x16x32_bf16 v[128:131], v[152:155], v[132:135], v[128:131]
    ds_read_b128 v[196:199], v211 offset:4096
    s_add_u32 s80, s80, 36864
    s_cmp_eq_u32 s80, 147456
    s_cselect_b32 s80, 0, s80
    s_waitcnt lgkmcnt(6)
    v_mfma_f32_16x16x32_bf16 v[128:131], v[168:171], v[132:135], v[128:131]
    v_add_u32 v206, s80, v200
    v_add_u32 v207, s80, v201
    v_mfma_f32_32x32x16_bf16 v[64:79], v[168:171], v[176:179], v[64:79]
    v_add_u32 v208, s80, v202
    v_mfma_f32_32x32x16_bf16 v[80:95], v[168:171], v[180:183], v[80:95]
    v_add_u32 v209, s80, v203
    v_mfma_f32_32x32x16_bf16 v[96:111], v[172:175], v[176:179], v[96:111]
    v_add_u32 v210, s80, v204
    v_mfma_f32_32x32x16_bf16 v[112:127], v[172:175], v[180:183], v[112:127]
    v_add_u32 v211, s80, v205
    s_waitcnt lgkmcnt(0)
    s_barrier
    v_mfma_f32_32x32x16_bf16 v[64:79], v[184:187], v[192:195], v[64:79]
    ds_read_b64_tr_b16 v[136:137], v206 offset:0
    ds_read_b64_tr_b16 v[138:139], v206 offset:1024
    ds_read_b64_tr_b16 v[140:141], v207 offset:0
    v_mfma_f32_32x32x16_bf16 v[80:95], v[184:187], v[196:199], v[80:95]
    ds_read_b64_tr_b16 v[142:143], v207 offset:1024
    ds_read_b128 v[144:147], v208 offset:0
    v_mfma_f32_32x32x16_bf16 v[96:111], v[188:191], v[192:195], v[96:111]
    ds_read_b128 v[148:151], v208 offset:4096
    ds_read_b64_tr_b16 v[152:153], v206 offset:4096
    ds_read_b64_tr_b16 v[154:155], v206 offset:5120
    v_mfma_f32_32x32x16_bf16 v[112:127], v[188:191], v[196:199], v[112:127]
    ds_read_b64_tr_b16 v[156:157], v207 offset:4096
    ds_read_b64_tr_b16 v[158:159], v207 offset:5120
    v_mfma_f32_16x16x32_bf16 v[128:131], v[184:187], v[132:135], v[128:131]
    ds_read_b128 v[160:163], v209 offset:0
    ds_read_b128 v[164:167], v209 offset:4096
    s_waitcnt lgkmcnt(6)
    v_mfma_f32_32x32x16_bf16 v[64:79], v[136:139], v[144:147], v[64:79]
    ds_read_b64_tr_b16 v[168:169], v206 offset:8192
    ds_read_b64_tr_b16 v[170:171], v206 offset:9216
    v_mfma_f32_32x32x16_bf16 v[80:95], v[136:139], v[148:151], v[80:95]
    ds_read_b64_tr_b16 v[172:173], v207 offset:8192
    v_mfma_f32_32x32x16_bf16 v[96:111], v[140:143], v[144:147], v[96:111]
    ds_read_b64_tr_b16 v[174:175], v207 offset:9216
    v_mfma_f32_32x32x16_bf16 v[112:127], v[140:143], v[148:151], v[112:127]
    ds_read_b128 v[176:179], v210 offset:0
    v_mfma_f32_16x16x32_bf16 v[128:131], v[136:139], v[132:135], v[128:131]
    ds_read_b128 v[180:183], v210 offset:4096
    s_waitcnt lgkmcnt(6)
    v_mfma_f32_32x32x16_bf16 v[64:79], v[152:155], v[160:163], v[64:79]
    ds_read_b64_tr_b16 v[184:185], v206 offset:12288
    ds_read_b64_tr_b16 v[186:187], v206 offset:13312
    v_mfma_f32_32x32x16_bf16 v[80:95], v[152:155], v[164:167], v[80:95]
    ds_read_b64_tr_b16 v[188:189], v207 offset:12288
    v_mfma_f32_32x32x16_bf16 v[96:111], v[156:159], v[160:163], v[96:111]
    ds_read_b64_tr_b16 v[190:191], v207 offset:13312
    v_mfma_f32_32x32x16_bf16 v[112:127], v[156:159], v[164:167], v[112:127]
    ds_read_b128 v[192:195], v211 offset:0
    v_mfma_f32_16x16x32_bf16 v[128:131], v[152:155], v[132:135], v[128:131]
    ds_read_b128 v[196:199], v211 offset:4096
    s_add_u32 s80, s80, 36864
    s_cmp_eq_u32 s80, 147456
    s_cselect_b32 s80, 0, s80
    s_waitcnt lgkmcnt(6)
    v_mfma_f32_16x16x32_bf16 v[128:131], v[168:171], v[132:135], v[128:131]
    v_add_u32 v206, s80, v200
    v_add_u32 v207, s80, v201
    v_mfma_f32_32x32x16_bf16 v[64:79], v[168:171], v[176:179], v[64:79]
    v_add_u32 v208, s80, v202
    v_mfma_f32_32x32x16_bf16 v[80:95], v[168:171], v[180:183], v[80:95]
    v_add_u32 v209, s80, v203
    v_mfma_f32_32x32x16_bf16 v[96:111], v[172:175], v[176:179], v[96:111]
    v_add_u32 v210, s80, v204
    v_mfma_f32_32x32x16_bf16 v[112:127], v[172:175], v[180:183], v[112:127]
    v_add_u32 v211, s80, v205
    s_waitcnt lgkmcnt(0)
    s_waitcnt vmcnt(0)
    s_barrier
    v_mfma_f32_32x32x16_bf16 v[64:79], v[184:187], v[192:195], v[64:79]
    ds_read_b64_tr_b16 v[136:137], v206 offset:0
    ds_read_b64_tr_b16 v[138:139], v206 offset:1024
    ds_read_b64_tr_b16 v[140:141], v207 offset:0
    v_mfma_f32_32x32x16_bf16 v[80:95], v[184:187], v[196:199], v[80:95]
    ds_read_b64_tr_b16 v[142:143], v207 offset:1024
    ds_read_b128 v[144:147], v208 offset:0
    v_mfma_f32_32x32x16_bf16 v[96:111], v[188:191], v[192:195], v[96:111]
    ds_read_b128 v[148:151], v208 offset:4096
    ds_read_b64_tr_b16 v[152:153], v206 offset:4096
    ds_read_b64_tr_b16 v[154:155], v206 offset:5120
    v_mfma_f32_32x32x16_bf16 v[112:127], v[188:191], v[196:199], v[112:127]
    ds_read_b64_tr_b16 v[156:157], v207 offset:4096
    ds_read_b64_tr_b16 v[158:159], v207 offset:5120
    v_mfma_f32_16x16x32_bf16 v[128:131], v[184:187], v[132:135], v[128:131]
    ds_read_b128 v[160:163], v209 offset:0
    ds_read_b128 v[164:167], v209 offset:4096
    s_waitcnt lgkmcnt(6)
    v_mfma_f32_32x32x16_bf16 v[64:79], v[136:139], v[144:147], v[64:79]
    ds_read_b64_tr_b16 v[168:169], v206 offset:8192
    ds_read_b64_tr_b16 v[170:171], v206 offset:9216
    v_mfma_f32_32x32x16_bf16 v[80:95], v[136:139], v[148:151], v[80:95]
    ds_read_b64_tr_b16 v[172:173], v207 offset:8192
    v_mfma_f32_32x32x16_bf16 v[96:111], v[140:143], v[144:147], v[96:111]
    ds_read_b64_tr_b16 v[174:175], v207 offset:9216
    v_mfma_f32_32x32x16_bf16 v[112:127], v[140:143], v[148:151], v[112:127]
    ds_read_b128 v[176:179], v210 offset:0
    v_mfma_f32_16x16x32_bf16 v[128:131], v[136:139], v[132:135], v[128:131]
    ds_read_b128 v[180:183], v210 offset:4096
    s_waitcnt lgkmcnt(6)
    v_mfma_f32_32x32x16_bf16 v[64:79], v[152:155], v[160:163], v[64:79]
    ds_read_b64_tr_b16 v[184:185], v206 offset:12288
    ds_read_b64_tr_b16 v[186:187], v206 offset:13312
    v_mfma_f32_32x32x16_bf16 v[80:95], v[152:155], v[164:167], v[80:95]
    ds_read_b64_tr_b16 v[188:189], v207 offset:12288
    v_mfma_f32_32x32x16_bf16 v[96:111], v[156:159], v[160:163], v[96:111]
    ds_read_b64_tr_b16 v[190:191], v207 offset:13312
    v_mfma_f32_32x32x16_bf16 v[112:127], v[156:159], v[164:167], v[112:127]
    ds_read_b128 v[192:195], v211 offset:0
    v_mfma_f32_16x16x32_bf16 v[128:131], v[152:155], v[132:135], v[128:131]
    ds_read_b128 v[196:199], v211 offset:4096
    s_add_u32 s80, s80, 36864
    s_cmp_eq_u32 s80, 147456
    s_cselect_b32 s80, 0, s80
    s_waitcnt lgkmcnt(6)
    v_mfma_f32_16x16x32_bf16 v[128:131], v[168:171], v[132:135], v[128:131]
    v_add_u32 v206, s80, v200
    v_add_u32 v207, s80, v201
    v_mfma_f32_32x32x16_bf16 v[64:79], v[168:171], v[176:179], v[64:79]
    v_add_u32 v208, s80, v202
    v_mfma_f32_32x32x16_bf16 v[80:95], v[168:171], v[180:183], v[80:95]
    v_add_u32 v209, s80, v203
    v_mfma_f32_32x32x16_bf16 v[96:111], v[172:175], v[176:179], v[96:111]
    v_add_u32 v210, s80, v204
    v_mfma_f32_32x32x16_bf16 v[112:127], v[172:175], v[180:183], v[112:127]
    v_add_u32 v211, s80, v205
    s_waitcnt lgkmcnt(0)
    s_mov_b32 s81, 5
Lloop_1038:
    s_barrier
    v_mfma_f32_32x32x16_bf16 v[64:79], v[184:187], v[192:195], v[64:79]
    ds_read_b64_tr_b16 v[136:137], v206 offset:0
    ds_read_b64_tr_b16 v[138:139], v206 offset:1024
    ds_read_b64_tr_b16 v[140:141], v207 offset:0
    v_mfma_f32_32x32x16_bf16 v[80:95], v[184:187], v[196:199], v[80:95]
    ds_read_b64_tr_b16 v[142:143], v207 offset:1024
    ds_read_b128 v[144:147], v208 offset:0
    v_mfma_f32_32x32x16_bf16 v[96:111], v[188:191], v[192:195], v[96:111]
    ds_read_b128 v[148:151], v208 offset:4096
    ds_read_b64_tr_b16 v[152:153], v206 offset:4096
    ds_read_b64_tr_b16 v[154:155], v206 offset:5120
    v_mfma_f32_32x32x16_bf16 v[112:127], v[188:191], v[196:199], v[112:127]
    ds_read_b64_tr_b16 v[156:157], v207 offset:4096
    ds_read_b64_tr_b16 v[158:159], v207 offset:5120
    v_mfma_f32_16x16x32_bf16 v[128:131], v[184:187], v[132:135], v[128:131]
    ds_read_b128 v[160:163], v209 offset:0
    ds_read_b128 v[164:167], v209 offset:4096
    s_waitcnt lgkmcnt(6)
    v_mfma_f32_32x32x16_bf16 v[64:79], v[136:139], v[144:147], v[64:79]
    ds_read_b64_tr_b16 v[168:169], v206 offset:8192
    ds_read_b64_tr_b16 v[170:171], v206 offset:9216
    v_mfma_f32_32x32x16_bf16 v[80:95], v[136:139], v[148:151], v[80:95]
    ds_read_b64_tr_b16 v[172:173], v207 offset:8192
    v_mfma_f32_32x32x16_bf16 v[96:111], v[140:143], v[144:147], v[96:111]
    ds_read_b64_tr_b16 v[174:175], v207 offset:9216
    v_mfma_f32_32x32x16_bf16 v[112:127], v[140:143], v[148:151], v[112:127]
    ds_read_b128 v[176:179], v210 offset:0
    v_mfma_f32_16x16x32_bf16 v[128:131], v[136:139], v[132:135], v[128:131]
    ds_read_b128 v[180:183], v210 offset:4096
    s_waitcnt lgkmcnt(6)
    v_mfma_f32_32x32x16_bf16 v[64:79], v[152:155], v[160:163], v[64:79]
    ds_read_b64_tr_b16 v[184:185], v206 offset:12288
    ds_read_b64_tr_b16 v[186:187], v206 offset:13312
    v_mfma_f32_32x32x16_bf16 v[80:95], v[152:155], v[164:167], v[80:95]
    ds_read_b64_tr_b16 v[188:189], v207 offset:12288
    v_mfma_f32_32x32x16_bf16 v[96:111], v[156:159], v[160:163], v[96:111]
    ds_read_b64_tr_b16 v[190:191], v207 offset:13312
    v_mfma_f32_32x32x16_bf16 v[112:127], v[156:159], v[164:167], v[112:127]
    ds_read_b128 v[192:195], v211 offset:0
    v_mfma_f32_16x16x32_bf16 v[128:131], v[152:155], v[132:135], v[128:131]
    ds_read_b128 v[196:199], v211 offset:4096
    s_add_u32 s80, s80, 36864
    s_cmp_eq_u32 s80, 147456
    s_cselect_b32 s80, 0, s80
    s_waitcnt lgkmcnt(6)
    v_mfma_f32_16x16x32_bf16 v[128:131], v[168:171], v[132:135], v[128:131]
    v_add_u32 v206, s80, v200
    v_add_u32 v207, s80, v201
    v_mfma_f32_32x32x16_bf16 v[64:79], v[168:171], v[176:179], v[64:79]
    v_add_u32 v208, s80, v202
    v_mfma_f32_32x32x16_bf16 v[80:95], v[168:171], v[180:183], v[80:95]
    v_add_u32 v209, s80, v203
    v_mfma_f32_32x32x16_bf16 v[96:111], v[172:175], v[176:179], v[96:111]
    v_add_u32 v210, s80, v204
    v_mfma_f32_32x32x16_bf16 v[112:127], v[172:175], v[180:183], v[112:127]
    v_add_u32 v211, s80, v205
    s_waitcnt lgkmcnt(0)
    s_sub_u32 s81, s81, 1
    s_cmp_lg_u32 s81, 0
    s_cbranch_scc1 Lloop_1038
    s_barrier
    s_lshl_b32 s86, s70, 7
    s_lshl_b32 s87, s95, 6
    s_add_u32 s86, s86, s87
    v_and_b32 v213, 31, v0
    v_add_u32 v213, s86, v213
    v_lshlrev_b32 v213, 3, v213
    v_add_u32 v213, 16384, v213
    buffer_load_dwordx2 v[48:49], v213, s[48:51], 0 offen sc1
    buffer_load_dwordx2 v[50:51], v213, s[48:51], 0 offen offset:256 sc1
    v_mfma_f32_32x32x16_bf16 v[64:79], v[184:187], v[192:195], v[64:79]
    ds_read_b64_tr_b16 v[136:137], v206 offset:0
    ds_read_b64_tr_b16 v[138:139], v206 offset:1024
    ds_read_b64_tr_b16 v[140:141], v207 offset:0
    v_mfma_f32_32x32x16_bf16 v[80:95], v[184:187], v[196:199], v[80:95]
    ds_read_b64_tr_b16 v[142:143], v207 offset:1024
    ds_read_b128 v[144:147], v208 offset:0
    v_mfma_f32_32x32x16_bf16 v[96:111], v[188:191], v[192:195], v[96:111]
    ds_read_b128 v[148:151], v208 offset:4096
    ds_read_b64_tr_b16 v[152:153], v206 offset:4096
    ds_read_b64_tr_b16 v[154:155], v206 offset:5120
    v_mfma_f32_32x32x16_bf16 v[112:127], v[188:191], v[196:199], v[112:127]
    ds_read_b64_tr_b16 v[156:157], v207 offset:4096
    ds_read_b64_tr_b16 v[158:159], v207 offset:5120
    v_mfma_f32_16x16x32_bf16 v[128:131], v[184:187], v[132:135], v[128:131]
    ds_read_b128 v[160:163], v209 offset:0
    ds_read_b128 v[164:167], v209 offset:4096
    s_waitcnt lgkmcnt(6)
    v_mfma_f32_32x32x16_bf16 v[64:79], v[136:139], v[144:147], v[64:79]
    ds_read_b64_tr_b16 v[168:169], v206 offset:8192
    ds_read_b64_tr_b16 v[170:171], v206 offset:9216
    v_mfma_f32_32x32x16_bf16 v[80:95], v[136:139], v[148:151], v[80:95]
    ds_read_b64_tr_b16 v[172:173], v207 offset:8192
    v_mfma_f32_32x32x16_bf16 v[96:111], v[140:143], v[144:147], v[96:111]
    ds_read_b64_tr_b16 v[174:175], v207 offset:9216
    v_mfma_f32_32x32x16_bf16 v[112:127], v[140:143], v[148:151], v[112:127]
    ds_read_b128 v[176:179], v210 offset:0
    v_mfma_f32_16x16x32_bf16 v[128:131], v[136:139], v[132:135], v[128:131]
    ds_read_b128 v[180:183], v210 offset:4096
    s_waitcnt lgkmcnt(6)
    v_mfma_f32_32x32x16_bf16 v[64:79], v[152:155], v[160:163], v[64:79]
    ds_read_b64_tr_b16 v[184:185], v206 offset:12288
    ds_read_b64_tr_b16 v[186:187], v206 offset:13312
    v_mfma_f32_32x32x16_bf16 v[80:95], v[152:155], v[164:167], v[80:95]
    ds_read_b64_tr_b16 v[188:189], v207 offset:12288
    v_mfma_f32_32x32x16_bf16 v[96:111], v[156:159], v[160:163], v[96:111]
    ds_read_b64_tr_b16 v[190:191], v207 offset:13312
    v_mfma_f32_32x32x16_bf16 v[112:127], v[156:159], v[164:167], v[112:127]
    ds_read_b128 v[192:195], v211 offset:0
    v_mfma_f32_16x16x32_bf16 v[128:131], v[152:155], v[132:135], v[128:131]
    ds_read_b128 v[196:199], v211 offset:4096
    s_add_u32 s80, s80, 36864
    s_cmp_eq_u32 s80, 147456
    s_cselect_b32 s80, 0, s80
    s_waitcnt lgkmcnt(6)
    v_mfma_f32_16x16x32_bf16 v[128:131], v[168:171], v[132:135], v[128:131]
    v_add_u32 v206, s80, v200
    v_add_u32 v207, s80, v201
    v_mfma_f32_32x32x16_bf16 v[64:79], v[168:171], v[176:179], v[64:79]
    v_add_u32 v208, s80, v202
    v_mfma_f32_32x32x16_bf16 v[80:95], v[168:171], v[180:183], v[80:95]
    v_add_u32 v209, s80, v203
    v_mfma_f32_32x32x16_bf16 v[96:111], v[172:175], v[176:179], v[96:111]
    v_add_u32 v210, s80, v204
    v_mfma_f32_32x32x16_bf16 v[112:127], v[172:175], v[180:183], v[112:127]
    v_add_u32 v211, s80, v205
    s_waitcnt lgkmcnt(0)
    s_barrier
    v_mfma_f32_32x32x16_bf16 v[64:79], v[184:187], v[192:195], v[64:79]
    ds_read_b64_tr_b16 v[136:137], v206 offset:0
    ds_read_b64_tr_b16 v[138:139], v206 offset:1024
    ds_read_b64_tr_b16 v[140:141], v207 offset:0
    v_mfma_f32_32x32x16_bf16 v[80:95], v[184:187], v[196:199], v[80:95]
    ds_read_b64_tr_b16 v[142:143], v207 offset:1024
    ds_read_b128 v[144:147], v208 offset:0
    v_mfma_f32_32x32x16_bf16 v[96:111], v[188:191], v[192:195], v[96:111]
    ds_read_b128 v[148:151], v208 offset:4096
    ds_read_b64_tr_b16 v[152:153], v206 offset:4096
    ds_read_b64_tr_b16 v[154:155], v206 offset:5120
    v_mfma_f32_32x32x16_bf16 v[112:127], v[188:191], v[196:199], v[112:127]
    ds_read_b64_tr_b16 v[156:157], v207 offset:4096
    ds_read_b64_tr_b16 v[158:159], v207 offset:5120
    v_mfma_f32_16x16x32_bf16 v[128:131], v[184:187], v[132:135], v[128:131]
    ds_read_b128 v[160:163], v209 offset:0
    ds_read_b128 v[164:167], v209 offset:4096
    s_waitcnt lgkmcnt(6)
    v_mfma_f32_32x32x16_bf16 v[64:79], v[136:139], v[144:147], v[64:79]
    ds_read_b64_tr_b16 v[168:169], v206 offset:8192
    ds_read_b64_tr_b16 v[170:171], v206 offset:9216
    v_mfma_f32_32x32x16_bf16 v[80:95], v[136:139], v[148:151], v[80:95]
    ds_read_b64_tr_b16 v[172:173], v207 offset:8192
    v_mfma_f32_32x32x16_bf16 v[96:111], v[140:143], v[144:147], v[96:111]
    ds_read_b64_tr_b16 v[174:175], v207 offset:9216
    v_mfma_f32_32x32x16_bf16 v[112:127], v[140:143], v[148:151], v[112:127]
    ds_read_b128 v[176:179], v210 offset:0
    v_mfma_f32_16x16x32_bf16 v[128:131], v[136:139], v[132:135], v[128:131]
    ds_read_b128 v[180:183], v210 offset:4096
    s_waitcnt lgkmcnt(6)
    v_mfma_f32_32x32x16_bf16 v[64:79], v[152:155], v[160:163], v[64:79]
    ds_read_b64_tr_b16 v[184:185], v206 offset:12288
    ds_read_b64_tr_b16 v[186:187], v206 offset:13312
    v_mfma_f32_32x32x16_bf16 v[80:95], v[152:155], v[164:167], v[80:95]
    ds_read_b64_tr_b16 v[188:189], v207 offset:12288
    v_mfma_f32_32x32x16_bf16 v[96:111], v[156:159], v[160:163], v[96:111]
    ds_read_b64_tr_b16 v[190:191], v207 offset:13312
    v_mfma_f32_32x32x16_bf16 v[112:127], v[156:159], v[164:167], v[112:127]
    ds_read_b128 v[192:195], v211 offset:0
    v_mfma_f32_16x16x32_bf16 v[128:131], v[152:155], v[132:135], v[128:131]
    ds_read_b128 v[196:199], v211 offset:4096
    s_add_u32 s80, s80, 36864
    s_cmp_eq_u32 s80, 147456
    s_cselect_b32 s80, 0, s80
    s_waitcnt lgkmcnt(6)
    v_mfma_f32_16x16x32_bf16 v[128:131], v[168:171], v[132:135], v[128:131]
    v_add_u32 v206, s80, v200
    v_add_u32 v207, s80, v201
    v_mfma_f32_32x32x16_bf16 v[64:79], v[168:171], v[176:179], v[64:79]
    v_add_u32 v208, s80, v202
    v_mfma_f32_32x32x16_bf16 v[80:95], v[168:171], v[180:183], v[80:95]
    v_add_u32 v209, s80, v203
    v_mfma_f32_32x32x16_bf16 v[96:111], v[172:175], v[176:179], v[96:111]
    v_add_u32 v210, s80, v204
    v_mfma_f32_32x32x16_bf16 v[112:127], v[172:175], v[180:183], v[112:127]
    v_add_u32 v211, s80, v205
    s_waitcnt lgkmcnt(0)
    v_mfma_f32_16x16x32_bf16 v[128:131], v[184:187], v[132:135], v[128:131]
    v_mfma_f32_32x32x16_bf16 v[64:79], v[184:187], v[192:195], v[64:79]
    v_mfma_f32_32x32x16_bf16 v[80:95], v[184:187], v[196:199], v[80:95]
    v_mfma_f32_32x32x16_bf16 v[96:111], v[188:191], v[192:195], v[96:111]
    v_mfma_f32_32x32x16_bf16 v[112:127], v[188:191], v[196:199], v[112:127]
    s_nop 7
    s_branch Lsele_1036
Lsel_1035:
    s_barrier
    s_cmp_eq_u32 s18, 0
    s_cbranch_scc1 Lnoln_1039
    buffer_store_dwordx2 v[212:213], v224, s[48:51], 0 offen offset:0 sc1
    buffer_store_dwordx2 v[214:215], v224, s[48:51], 0 offen offset:256 sc1
    buffer_store_dwordx2 v[216:217], v224, s[48:51], 0 offen offset:512 sc1
    buffer_store_dwordx2 v[218:219], v224, s[48:51], 0 offen offset:768 sc1
    buffer_store_dwordx2 v[220:221], v224, s[48:51], 0 offen offset:1024 sc1
    buffer_store_dwordx2 v[222:223], v225, s[48:51], 0 offen sc1
Lnoln_1039:
    ds_read_b64_tr_b16 v[136:137], v206 offset:0
    ds_read_b64_tr_b16 v[138:139], v206 offset:1024
    ds_read_b64_tr_b16 v[140:141], v207 offset:0
    ds_read_b64_tr_b16 v[142:143], v207 offset:1024
    ds_read_b128 v[144:147], v208 offset:0
    ds_read_b128 v[148:151], v208 offset:4096
    ds_read_b64_tr_b16 v[152:153], v206 offset:4096
    ds_read_b64_tr_b16 v[154:155], v206 offset:5120
    ds_read_b64_tr_b16 v[156:157], v207 offset:4096
    ds_read_b64_tr_b16 v[158:159], v207 offset:5120
    ds_read_b128 v[160:163], v209 offset:0
    ds_read_b128 v[164:167], v209 offset:4096
    s_waitcnt lgkmcnt(6)
    v_mfma_f32_32x32x16_bf16 v[64:79], v[136:139], v[144:147], 0
    ds_read_b64_tr_b16 v[168:169], v206 offset:8192
    ds_read_b64_tr_b16 v[170:171], v206 offset:9216
    v_mfma_f32_32x32x16_bf16 v[80:95], v[136:139], v[148:151], 0
    ds_read_b64_tr_b16 v[172:173], v207 offset:8192
    v_mfma_f32_32x32x16_bf16 v[96:111], v[140:143], v[144:147], 0
    ds_read_b64_tr_b16 v[174:175], v207 offset:9216
    v_mfma_f32_32x32x16_bf16 v[112:127], v[140:143], v[148:151], 0
    ds_read_b128 v[176:179], v210 offset:0
    v_mfma_f32_16x16x32_bf16 v[128:131], v[140:143], v[132:135], 0
    ds_read_b128 v[180:183], v210 offset:4096
    s_waitcnt lgkmcnt(6)
    v_mfma_f32_32x32x16_bf16 v[64:79], v[152:155], v[160:163], v[64:79]
    ds_read_b64_tr_b16 v[184:185], v206 offset:12288
    ds_read_b64_tr_b16 v[186:187], v206 offset:13312
    v_mfma_f32_32x32x16_bf16 v[80:95], v[152:155], v[164:167], v[80:95]
    ds_read_b64_tr_b16 v[188:189], v207 offset:12288
    v_mfma_f32_32x32x16_bf16 v[96:111], v[156:159], v[160:163], v[96:111]
    ds_read_b64_tr_b16 v[190:191], v207 offset:13312
    v_mfma_f32_32x32x16_bf16 v[112:127], v[156:159], v[164:167], v[112:127]
    ds_read_b128 v[192:195], v211 offset:0
    v_mfma_f32_16x16x32_bf16 v[128:131], v[156:159], v[132:135], v[128:131]
    ds_read_b128 v[196:199], v211 offset:4096
    s_add_u32 s80, s80, 36864
    s_cmp_eq_u32 s80, 147456
    s_cselect_b32 s80, 0, s80
    s_waitcnt lgkmcnt(6)
    v_mfma_f32_16x16x32_bf16 v[128:131], v[172:175], v[132:135], v[128:131]
    v_add_u32 v206, s80, v200
    v_add_u32 v207, s80, v201
    v_mfma_f32_32x32x16_bf16 v[64:79], v[168:171], v[176:179], v[64:79]
    v_add_u32 v208, s80, v202
    v_mfma_f32_32x32x16_bf16 v[80:95], v[168:171], v[180:183], v[80:95]
    v_add_u32 v209, s80, v203
    v_mfma_f32_32x32x16_bf16 v[96:111], v[172:175], v[176:179], v[96:111]
    v_add_u32 v210, s80, v204
    v_mfma_f32_32x32x16_bf16 v[112:127], v[172:175], v[180:183], v[112:127]
    v_add_u32 v211, s80, v205
    s_waitcnt lgkmcnt(0)
    s_barrier
    v_mfma_f32_32x32x16_bf16 v[64:79], v[184:187], v[192:195], v[64:79]
    ds_read_b64_tr_b16 v[136:137], v206 offset:0
    ds_read_b64_tr_b16 v[138:139], v206 offset:1024
    ds_read_b64_tr_b16 v[140:141], v207 offset:0
    v_mfma_f32_32x32x16_bf16 v[80:95], v[184:187], v[196:199], v[80:95]
    ds_read_b64_tr_b16 v[142:143], v207 offset:1024
    ds_read_b128 v[144:147], v208 offset:0
    v_mfma_f32_32x32x16_bf16 v[96:111], v[188:191], v[192:195], v[96:111]
    ds_read_b128 v[148:151], v208 offset:4096
    ds_read_b64_tr_b16 v[152:153], v206 offset:4096
    ds_read_b64_tr_b16 v[154:155], v206 offset:5120
    v_mfma_f32_32x32x16_bf16 v[112:127], v[188:191], v[196:199], v[112:127]
    ds_read_b64_tr_b16 v[156:157], v207 offset:4096
    ds_read_b64_tr_b16 v[158:159], v207 offset:5120
    v_mfma_f32_16x16x32_bf16 v[128:131], v[188:191], v[132:135], v[128:131]
    ds_read_b128 v[160:163], v209 offset:0
    ds_read_b128 v[164:167], v209 offset:4096
    s_waitcnt lgkmcnt(6)
    v_mfma_f32_32x32x16_bf16 v[64:79], v[136:139], v[144:147], v[64:79]
    ds_read_b64_tr_b16 v[168:169], v206 offset:8192
    ds_read_b64_tr_b16 v[170:171], v206 offset:9216
    v_mfma_f32_32x32x16_bf16 v[80:95], v[136:139], v[148:151], v[80:95]
    ds_read_b64_tr_b16 v[172:173], v207 offset:8192
    v_mfma_f32_32x32x16_bf16 v[96:111], v[140:143], v[144:147], v[96:111]
    ds_read_b64_tr_b16 v[174:175], v207 offset:9216
    v_mfma_f32_32x32x16_bf16 v[112:127], v[140:143], v[148:151], v[112:127]
    ds_read_b128 v[176:179], v210 offset:0
    v_mfma_f32_16x16x32_bf16 v[128:131], v[140:143], v[132:135], v[128:131]
    ds_read_b128 v[180:183], v210 offset:4096
    s_waitcnt lgkmcnt(6)
    v_mfma_f32_32x32x16_bf16 v[64:79], v[152:155], v[160:163], v[64:79]
    ds_read_b64_tr_b16 v[184:185], v206 offset:12288
    ds_read_b64_tr_b16 v[186:187], v206 offset:13312
    v_mfma_f32_32x32x16_bf16 v[80:95], v[152:155], v[164:167], v[80:95]
    ds_read_b64_tr_b16 v[188:189], v207 offset:12288
    v_mfma_f32_32x32x16_bf16 v[96:111], v[156:159], v[160:163], v[96:111]
    ds_read_b64_tr_b16 v[190:191], v207 offset:13312
    v_mfma_f32_32x32x16_bf16 v[112:127], v[156:159], v[164:167], v[112:127]
    ds_read_b128 v[192:195], v211 offset:0
    v_mfma_f32_16x16x32_bf16 v[128:131], v[156:159], v[132:135], v[128:131]
    ds_read_b128 v[196:199], v211 offset:4096
    s_add_u32 s80, s80, 36864
    s_cmp_eq_u32 s80, 147456
    s_cselect_b32 s80, 0, s80
    s_waitcnt lgkmcnt(6)
    v_mfma_f32_16x16x32_bf16 v[128:131], v[172:175], v[132:135], v[128:131]
    v_add_u32 v206, s80, v200
    v_add_u32 v207, s80, v201
    v_mfma_f32_32x32x16_bf16 v[64:79], v[168:171], v[176:179], v[64:79]
    v_add_u32 v208, s80, v202
    v_mfma_f32_32x32x16_bf16 v[80:95], v[168:171], v[180:183], v[80:95]
    v_add_u32 v209, s80, v203
    v_mfma_f32_32x32x16_bf16 v[96:111], v[172:175], v[176:179], v[96:111]
    v_add_u32 v210, s80, v204
    v_mfma_f32_32x32x16_bf16 v[112:127], v[172:175], v[180:183], v[112:127]
    v_add_u32 v211, s80, v205
    s_waitcnt lgkmcnt(0)
    s_waitcnt vmcnt(0)
    s_barrier
    v_mfma_f32_32x32x16_bf16 v[64:79], v[184:187], v[192:195], v[64:79]
    ds_read_b64_tr_b16 v[136:137], v206 offset:0
    ds_read_b64_tr_b16 v[138:139], v206 offset:1024
    ds_read_b64_tr_b16 v[140:141], v207 offset:0
    v_mfma_f32_32x32x16_bf16 v[80:95], v[184:187], v[196:199], v[80:95]
    ds_read_b64_tr_b16 v[142:143], v207 offset:1024
    ds_read_b128 v[144:147], v208 offset:0
    v_mfma_f32_32x32x16_bf16 v[96:111], v[188:191], v[192:195], v[96:111]
    ds_read_b128 v[148:151], v208 offset:4096
    ds_read_b64_tr_b16 v[152:153], v206 offset:4096
    ds_read_b64_tr_b16 v[154:155], v206 offset:5120
    v_mfma_f32_32x32x16_bf16 v[112:127], v[188:191], v[196:199], v[112:127]
    ds_read_b64_tr_b16 v[156:157], v207 offset:4096
    ds_read_b64_tr_b16 v[158:159], v207 offset:5120
    v_mfma_f32_16x16x32_bf16 v[128:131], v[188:191], v[132:135], v[128:131]
    ds_read_b128 v[160:163], v209 offset:0
    ds_read_b128 v[164:167], v209 offset:4096
    s_waitcnt lgkmcnt(6)
    v_mfma_f32_32x32x16_bf16 v[64:79], v[136:139], v[144:147], v[64:79]
    ds_read_b64_tr_b16 v[168:169], v206 offset:8192
    ds_read_b64_tr_b16 v[170:171], v206 offset:9216
    v_mfma_f32_32x32x16_bf16 v[80:95], v[136:139], v[148:151], v[80:95]
    ds_read_b64_tr_b16 v[172:173], v207 offset:8192
    v_mfma_f32_32x32x16_bf16 v[96:111], v[140:143], v[144:147], v[96:111]
    ds_read_b64_tr_b16 v[174:175], v207 offset:9216
    v_mfma_f32_32x32x16_bf16 v[112:127], v[140:143], v[148:151], v[112:127]
    ds_read_b128 v[176:179], v210 offset:0
    v_mfma_f32_16x16x32_bf16 v[128:131], v[140:143], v[132:135], v[128:131]
    ds_read_b128 v[180:183], v210 offset:4096
    s_waitcnt lgkmcnt(6)
    v_mfma_f32_32x32x16_bf16 v[64:79], v[152:155], v[160:163], v[64:79]
    ds_read_b64_tr_b16 v[184:185], v206 offset:12288
    ds_read_b64_tr_b16 v[186:187], v206 offset:13312
    v_mfma_f32_32x32x16_bf16 v[80:95], v[152:155], v[164:167], v[80:95]
    ds_read_b64_tr_b16 v[188:189], v207 offset:12288
    v_mfma_f32_32x32x16_bf16 v[96:111], v[156:159], v[160:163], v[96:111]
    ds_read_b64_tr_b16 v[190:191], v207 offset:13312
    v_mfma_f32_32x32x16_bf16 v[112:127], v[156:159], v[164:167], v[112:127]
    ds_read_b128 v[192:195], v211 offset:0
    v_mfma_f32_16x16x32_bf16 v[128:131], v[156:159], v[132:135], v[128:131]
    ds_read_b128 v[196:199], v211 offset:4096
    s_add_u32 s80, s80, 36864
    s_cmp_eq_u32 s80, 147456
    s_cselect_b32 s80, 0, s80
    s_waitcnt lgkmcnt(6)
    v_mfma_f32_16x16x32_bf16 v[128:131], v[172:175], v[132:135], v[128:131]
    v_add_u32 v206, s80, v200
    v_add_u32 v207, s80, v201
    v_mfma_f32_32x32x16_bf16 v[64:79], v[168:171], v[176:179], v[64:79]
    v_add_u32 v208, s80, v202
    v_mfma_f32_32x32x16_bf16 v[80:95], v[168:171], v[180:183], v[80:95]
    v_add_u32 v209, s80, v203
    v_mfma_f32_32x32x16_bf16 v[96:111], v[172:175], v[176:179], v[96:111]
    v_add_u32 v210, s80, v204
    v_mfma_f32_32x32x16_bf16 v[112:127], v[172:175], v[180:183], v[112:127]
    v_add_u32 v211, s80, v205
    s_waitcnt lgkmcnt(0)
    s_mov_b32 s81, 5
Lloop_1040:
    s_barrier
    v_mfma_f32_32x32x16_bf16 v[64:79], v[184:187], v[192:195], v[64:79]
    ds_read_b64_tr_b16 v[136:137], v206 offset:0
    ds_read_b64_tr_b16 v[138:139], v206 offset:1024
    ds_read_b64_tr_b16 v[140:141], v207 offset:0
    v_mfma_f32_32x32x16_bf16 v[80:95], v[184:187], v[196:199], v[80:95]
    ds_read_b64_tr_b16 v[142:143], v207 offset:1024
    ds_read_b128 v[144:147], v208 offset:0
    v_mfma_f32_32x32x16_bf16 v[96:111], v[188:191], v[192:195], v[96:111]
    ds_read_b128 v[148:151], v208 offset:4096
    ds_read_b64_tr_b16 v[152:153], v206 offset:4096
    ds_read_b64_tr_b16 v[154:155], v206 offset:5120
    v_mfma_f32_32x32x16_bf16 v[112:127], v[188:191], v[196:199], v[112:127]
    ds_read_b64_tr_b16 v[156:157], v207 offset:4096
    ds_read_b64_tr_b16 v[158:159], v207 offset:5120
    v_mfma_f32_16x16x32_bf16 v[128:131], v[188:191], v[132:135], v[128:131]
    ds_read_b128 v[160:163], v209 offset:0
    ds_read_b128 v[164:167], v209 offset:4096
    s_waitcnt lgkmcnt(6)
    v_mfma_f32_32x32x16_bf16 v[64:79], v[136:139], v[144:147], v[64:79]
    ds_read_b64_tr_b16 v[168:169], v206 offset:8192
    ds_read_b64_tr_b16 v[170:171], v206 offset:9216
    v_mfma_f32_32x32x16_bf16 v[80:95], v[136:139], v[148:151], v[80:95]
    ds_read_b64_tr_b16 v[172:173], v207 offset:8192
    v_mfma_f32_32x32x16_bf16 v[96:111], v[140:143], v[144:147], v[96:111]
    ds_read_b64_tr_b16 v[174:175], v207 offset:9216
    v_mfma_f32_32x32x16_bf16 v[112:127], v[140:143], v[148:151], v[112:127]
    ds_read_b128 v[176:179], v210 offset:0
    v_mfma_f32_16x16x32_bf16 v[128:131], v[140:143], v[132:135], v[128:131]
    ds_read_b128 v[180:183], v210 offset:4096
    s_waitcnt lgkmcnt(6)
    v_mfma_f32_32x32x16_bf16 v[64:79], v[152:155], v[160:163], v[64:79]
    ds_read_b64_tr_b16 v[184:185], v206 offset:12288
    ds_read_b64_tr_b16 v[186:187], v206 offset:13312
    v_mfma_f32_32x32x16_bf16 v[80:95], v[152:155], v[164:167], v[80:95]
    ds_read_b64_tr_b16 v[188:189], v207 offset:12288
    v_mfma_f32_32x32x16_bf16 v[96:111], v[156:159], v[160:163], v[96:111]
    ds_read_b64_tr_b16 v[190:191], v207 offset:13312
    v_mfma_f32_32x32x16_bf16 v[112:127], v[156:159], v[164:167], v[112:127]
    ds_read_b128 v[192:195], v211 offset:0
    v_mfma_f32_16x16x32_bf16 v[128:131], v[156:159], v[132:135], v[128:131]
    ds_read_b128 v[196:199], v211 offset:4096
    s_add_u32 s80, s80, 36864
    s_cmp_eq_u32 s80, 147456
    s_cselect_b32 s80, 0, s80
    s_waitcnt lgkmcnt(6)
    v_mfma_f32_16x16x32_bf16 v[128:131], v[172:175], v[132:135], v[128:131]
    v_add_u32 v206, s80, v200
    v_add_u32 v207, s80, v201
    v_mfma_f32_32x32x16_bf16 v[64:79], v[168:171], v[176:179], v[64:79]
    v_add_u32 v208, s80, v202
    v_mfma_f32_32x32x16_bf16 v[80:95], v[168:171], v[180:183], v[80:95]
    v_add_u32 v209, s80, v203
    v_mfma_f32_32x32x16_bf16 v[96:111], v[172:175], v[176:179], v[96:111]
    v_add_u32 v210, s80, v204
    v_mfma_f32_32x32x16_bf16 v[112:127], v[172:175], v[180:183], v[112:127]
    v_add_u32 v211, s80, v205
    s_waitcnt lgkmcnt(0)
    s_sub_u32 s81, s81, 1
    s_cmp_lg_u32 s81, 0
    s_cbranch_scc1 Lloop_1040
    s_barrier
    s_lshl_b32 s86, s70, 7
    s_lshl_b32 s87, s95, 6
    s_add_u32 s86, s86, s87
    v_and_b32 v213, 31, v0
    v_add_u32 v213, s86, v213
    v_lshlrev_b32 v213, 3, v213
    v_add_u32 v213, 16384, v213
    buffer_load_dwordx2 v[48:49], v213, s[48:51], 0 offen sc1
    buffer_load_dwordx2 v[50:51], v213, s[48:51], 0 offen offset:256 sc1
    v_mfma_f32_32x32x16_bf16 v[64:79], v[184:187], v[192:195], v[64:79]
    ds_read_b64_tr_b16 v[136:137], v206 offset:0
    ds_read_b64_tr_b16 v[138:139], v206 offset:1024
    ds_read_b64_tr_b16 v[140:141], v207 offset:0
    v_mfma_f32_32x32x16_bf16 v[80:95], v[184:187], v[196:199], v[80:95]
    ds_read_b64_tr_b16 v[142:143], v207 offset:1024
    ds_read_b128 v[144:147], v208 offset:0
    v_mfma_f32_32x32x16_bf16 v[96:111], v[188:191], v[192:195], v[96:111]
    ds_read_b128 v[148:151], v208 offset:4096
    ds_read_b64_tr_b16 v[152:153], v206 offset:4096
    ds_read_b64_tr_b16 v[154:155], v206 offset:5120
    v_mfma_f32_32x32x16_bf16 v[112:127], v[188:191], v[196:199], v[112:127]
    ds_read_b64_tr_b16 v[156:157], v207 offset:4096
    ds_read_b64_tr_b16 v[158:159], v207 offset:5120
    v_mfma_f32_16x16x32_bf16 v[128:131], v[188:191], v[132:135], v[128:131]
    ds_read_b128 v[160:163], v209 offset:0
    ds_read_b128 v[164:167], v209 offset:4096
    s_waitcnt lgkmcnt(6)
    v_mfma_f32_32x32x16_bf16 v[64:79], v[136:139], v[144:147], v[64:79]
    ds_read_b64_tr_b16 v[168:169], v206 offset:8192
    ds_read_b64_tr_b16 v[170:171], v206 offset:9216
    v_mfma_f32_32x32x16_bf16 v[80:95], v[136:139], v[148:151], v[80:95]
    ds_read_b64_tr_b16 v[172:173], v207 offset:8192
    v_mfma_f32_32x32x16_bf16 v[96:111], v[140:143], v[144:147], v[96:111]
    ds_read_b64_tr_b16 v[174:175], v207 offset:9216
    v_mfma_f32_32x32x16_bf16 v[112:127], v[140:143], v[148:151], v[112:127]
    ds_read_b128 v[176:179], v210 offset:0
    v_mfma_f32_16x16x32_bf16 v[128:131], v[140:143], v[132:135], v[128:131]
    ds_read_b128 v[180:183], v210 offset:4096
    s_waitcnt lgkmcnt(6)
    v_mfma_f32_32x32x16_bf16 v[64:79], v[152:155], v[160:163], v[64:79]
    ds_read_b64_tr_b16 v[184:185], v206 offset:12288
    ds_read_b64_tr_b16 v[186:187], v206 offset:13312
    v_mfma_f32_32x32x16_bf16 v[80:95], v[152:155], v[164:167], v[80:95]
    ds_read_b64_tr_b16 v[188:189], v207 offset:12288
    v_mfma_f32_32x32x16_bf16 v[96:111], v[156:159], v[160:163], v[96:111]
    ds_read_b64_tr_b16 v[190:191], v207 offset:13312
    v_mfma_f32_32x32x16_bf16 v[112:127], v[156:159], v[164:167], v[112:127]
    ds_read_b128 v[192:195], v211 offset:0
    v_mfma_f32_16x16x32_bf16 v[128:131], v[156:159], v[132:135], v[128:131]
    ds_read_b128 v[196:199], v211 offset:4096
    s_add_u32 s80, s80, 36864
    s_cmp_eq_u32 s80, 147456
    s_cselect_b32 s80, 0, s80
    s_waitcnt lgkmcnt(6)
    v_mfma_f32_16x16x32_bf16 v[128:131], v[172:175], v[132:135], v[128:131]
    v_add_u32 v206, s80, v200
    v_add_u32 v207, s80, v201
    v_mfma_f32_32x32x16_bf16 v[64:79], v[168:171], v[176:179], v[64:79]
    v_add_u32 v208, s80, v202
    v_mfma_f32_32x32x16_bf16 v[80:95], v[168:171], v[180:183], v[80:95]
    v_add_u32 v209, s80, v203
    v_mfma_f32_32x32x16_bf16 v[96:111], v[172:175], v[176:179], v[96:111]
    v_add_u32 v210, s80, v204
    v_mfma_f32_32x32x16_bf16 v[112:127], v[172:175], v[180:183], v[112:127]
    v_add_u32 v211, s80, v205
    s_waitcnt lgkmcnt(0)
    s_barrier
    v_mfma_f32_32x32x16_bf16 v[64:79], v[184:187], v[192:195], v[64:79]
    ds_read_b64_tr_b16 v[136:137], v206 offset:0
    ds_read_b64_tr_b16 v[138:139], v206 offset:1024
    ds_read_b64_tr_b16 v[140:141], v207 offset:0
    v_mfma_f32_32x32x16_bf16 v[80:95], v[184:187], v[196:199], v[80:95]
    ds_read_b64_tr_b16 v[142:143], v207 offset:1024
    ds_read_b128 v[144:147], v208 offset:0
    v_mfma_f32_32x32x16_bf16 v[96:111], v[188:191], v[192:195], v[96:111]
    ds_read_b128 v[148:151], v208 offset:4096
    ds_read_b64_tr_b16 v[152:153], v206 offset:4096
    ds_read_b64_tr_b16 v[154:155], v206 offset:5120
    v_mfma_f32_32x32x16_bf16 v[112:127], v[188:191], v[196:199], v[112:127]
    ds_read_b64_tr_b16 v[156:157], v207 offset:4096
    ds_read_b64_tr_b16 v[158:159], v207 offset:5120
    v_mfma_f32_16x16x32_bf16 v[128:131], v[188:191], v[132:135], v[128:131]
    ds_read_b128 v[160:163], v209 offset:0
    ds_read_b128 v[164:167], v209 offset:4096
    s_waitcnt lgkmcnt(6)
    v_mfma_f32_32x32x16_bf16 v[64:79], v[136:139], v[144:147], v[64:79]
    ds_read_b64_tr_b16 v[168:169], v206 offset:8192
    ds_read_b64_tr_b16 v[170:171], v206 offset:9216
    v_mfma_f32_32x32x16_bf16 v[80:95], v[136:139], v[148:151], v[80:95]
    ds_read_b64_tr_b16 v[172:173], v207 offset:8192
    v_mfma_f32_32x32x16_bf16 v[96:111], v[140:143], v[144:147], v[96:111]
    ds_read_b64_tr_b16 v[174:175], v207 offset:9216
    v_mfma_f32_32x32x16_bf16 v[112:127], v[140:143], v[148:151], v[112:127]
    ds_read_b128 v[176:179], v210 offset:0
    v_mfma_f32_16x16x32_bf16 v[128:131], v[140:143], v[132:135], v[128:131]
    ds_read_b128 v[180:183], v210 offset:4096
    s_waitcnt lgkmcnt(6)
    v_mfma_f32_32x32x16_bf16 v[64:79], v[152:155], v[160:163], v[64:79]
    ds_read_b64_tr_b16 v[184:185], v206 offset:12288
    ds_read_b64_tr_b16 v[186:187], v206 offset:13312
    v_mfma_f32_32x32x16_bf16 v[80:95], v[152:155], v[164:167], v[80:95]
    ds_read_b64_tr_b16 v[188:189], v207 offset:12288
    v_mfma_f32_32x32x16_bf16 v[96:111], v[156:159], v[160:163], v[96:111]
    ds_read_b64_tr_b16 v[190:191], v207 offset:13312
    v_mfma_f32_32x32x16_bf16 v[112:127], v[156:159], v[164:167], v[112:127]
    ds_read_b128 v[192:195], v211 offset:0
    v_mfma_f32_16x16x32_bf16 v[128:131], v[156:159], v[132:135], v[128:131]
    ds_read_b128 v[196:199], v211 offset:4096
    s_add_u32 s80, s80, 36864
    s_cmp_eq_u32 s80, 147456
    s_cselect_b32 s80, 0, s80
    s_waitcnt lgkmcnt(6)
    v_mfma_f32_16x16x32_bf16 v[128:131], v[172:175], v[132:135], v[128:131]
    v_add_u32 v206, s80, v200
    v_add_u32 v207, s80, v201
    v_mfma_f32_32x32x16_bf16 v[64:79], v[168:171], v[176:179], v[64:79]
    v_add_u32 v208, s80, v202
    v_mfma_f32_32x32x16_bf16 v[80:95], v[168:171], v[180:183], v[80:95]
    v_add_u32 v209, s80, v203
    v_mfma_f32_32x32x16_bf16 v[96:111], v[172:175], v[176:179], v[96:111]
    v_add_u32 v210, s80, v204
    v_mfma_f32_32x32x16_bf16 v[112:127], v[172:175], v[180:183], v[112:127]
    v_add_u32 v211, s80, v205
    s_waitcnt lgkmcnt(0)
    v_mfma_f32_16x16x32_bf16 v[128:131], v[188:191], v[132:135], v[128:131]
    v_mfma_f32_32x32x16_bf16 v[64:79], v[184:187], v[192:195], v[64:79]
    v_mfma_f32_32x32x16_bf16 v[80:95], v[184:187], v[196:199], v[80:95]
    v_mfma_f32_32x32x16_bf16 v[96:111], v[188:191], v[192:195], v[96:111]
    v_mfma_f32_32x32x16_bf16 v[112:127], v[188:191], v[196:199], v[112:127]
    s_nop 7
Lsele_1036:
    v_lshrrev_b32 v178, 5, v0
    v_lshlrev_b32 v179, 4, v178
    s_lshl_b32 s86, s94, 8
    s_add_u32 s86, s86, 157696
    v_add_u32 v179, s86, v179
    s_lshl_b32 s87, s95, 6
    v_and_b32 v180, 31, v0
    v_add_u32 v180, s87, v180
    v_lshlrev_b32 v178, 3, v178
    v_mul_u32_u24 v181, 80, v180
    v_add_u32 v181, v181, v178
    v_add_u32 v181, 147456, v181
    v_mul_u32_u24 v182, 168, v180
    v_add_u32 v182, v182, v178
    v_add_u32 v182, 36864, v182
    s_waitcnt vmcnt(0)
    v_mov_b32 v168, v49
    v_mul_f32 v169, v48, v49
    v_mul_f32 v170, 0x3ea52b5c, v49
    v_mul_f32 v171, 0x3ea52b5c, v169
    v_mov_b32 v172, v51
    v_mul_f32 v173, v50, v51
    v_mul_f32 v174, 0x3ea52b5c, v51
    v_mul_f32 v175, 0x3ea52b5c, v173
    v_and_b32 v176, 1, v0
    v_lshlrev_b32 v176, 6, v176
    v_lshrrev_b32 v177, 4, v0
    v_lshl_add_u32 v176, v177, 4, v176
    s_lshl_b32 s86, s94, 8
    s_lshl_b32 s87, s95, 7
    s_add_u32 s86, s86, s87
    s_add_u32 s86, s86, 157696
    v_add_u32 v176, s86, v176
    v_and_b32 v177, 14, v0
    v_cmp_eq_u32 vcc, 0, v177
    s_nop 3
    s_and_saveexec_b64 s[92:93], vcc
    ds_write_b128 v176, v[128:131]
    s_mov_b64 exec, s[92:93]
    s_waitcnt lgkmcnt(0)
    s_barrier
    s_cmp_lg_u32 s94, 0
    s_cbranch_scc1 Lsel_1041
    ds_read_b128 v[136:139], v179 offset:0
    ds_read_b128 v[140:143], v179 offset:32
    ds_read_b128 v[144:147], v179 offset:64
    ds_read_b128 v[148:151], v179 offset:96
    ds_read_b128 v[152:155], v179 offset:128
    ds_read_b128 v[156:159], v179 offset:160
    ds_read_b128 v[160:163], v179 offset:192
    ds_read_b128 v[164:167], v179 offset:224
    v_pk_mul_f32 v[64:65], v[64:65], v[170:171] op_sel_hi:[1,0]
    v_pk_mul_f32 v[66:67], v[66:67], v[170:171] op_sel_hi:[1,0]
    v_pk_mul_f32 v[68:69], v[68:69], v[170:171] op_sel_hi:[1,0]
    v_pk_mul_f32 v[70:71], v[70:71], v[170:171] op_sel_hi:[1,0]
    v_pk_mul_f32 v[72:73], v[72:73], v[170:171] op_sel_hi:[1,0]
    v_pk_mul_f32 v[74:75], v[74:75], v[170:171] op_sel_hi:[1,0]
    v_pk_mul_f32 v[76:77], v[76:77], v[170:171] op_sel_hi:[1,0]
    v_pk_mul_f32 v[78:79], v[78:79], v[170:171] op_sel_hi:[1,0]
    v_pk_mul_f32 v[96:97], v[96:97], v[170:171] op_sel_hi:[1,0]
    v_pk_mul_f32 v[98:99], v[98:99], v[170:171] op_sel_hi:[1,0]
    v_pk_mul_f32 v[100:101], v[100:101], v[168:169] op_sel_hi:[1,0]
    v_pk_mul_f32 v[102:103], v[102:103], v[168:169] op_sel_hi:[1,0]
    v_pk_mul_f32 v[104:105], v[104:105], v[168:169] op_sel_hi:[1,0]
    v_pk_mul_f32 v[106:107], v[106:107], v[168:169] op_sel_hi:[1,0]
    v_pk_mul_f32 v[108:109], v[108:109], v[168:169] op_sel_hi:[1,0]
    v_pk_mul_f32 v[110:111], v[110:111], v[168:169] op_sel_hi:[1,0]
    v_pk_mul_f32 v[80:81], v[80:81], v[174:175] op_sel_hi:[1,0]
    v_pk_mul_f32 v[82:83], v[82:83], v[174:175] op_sel_hi:[1,0]
    v_pk_mul_f32 v[84:85], v[84:85], v[174:175] op_sel_hi:[1,0]
    v_pk_mul_f32 v[86:87], v[86:87], v[174:175] op_sel_hi:[1,0]
    v_pk_mul_f32 v[88:89], v[88:89], v[174:175] op_sel_hi:[1,0]
    v_pk_mul_f32 v[90:91], v[90:91], v[174:175] op_sel_hi:[1,0]
    v_pk_mul_f32 v[92:93], v[92:93], v[174:175] op_sel_hi:[1,0]
    v_pk_mul_f32 v[94:95], v[94:95], v[174:175] op_sel_hi:[1,0]
    v_pk_mul_f32 v[112:113], v[112:113], v[174:175] op_sel_hi:[1,0]
    v_pk_mul_f32 v[114:115], v[114:115], v[174:175] op_sel_hi:[1,0]
    v_pk_mul_f32 v[116:117], v[116:117], v[172:173] op_sel_hi:[1,0]
    v_pk_mul_f32 v[118:119], v[118:119], v[172:173] op_sel_hi:[1,0]
    v_pk_mul_f32 v[120:121], v[120:121], v[172:173] op_sel_hi:[1,0]
    v_pk_mul_f32 v[122:123], v[122:123], v[172:173] op_sel_hi:[1,0]
    v_pk_mul_f32 v[124:125], v[124:125], v[172:173] op_sel_hi:[1,0]
    v_pk_mul_f32 v[126:127], v[126:127], v[172:173] op_sel_hi:[1,0]
    s_waitcnt lgkmcnt(0)
    v_pk_fma_f32 v[64:65], v[136:137], v[170:171], v[64:65] op_sel:[0,1,0] op_sel_hi:[1,1,1] neg_lo:[1,0,0] neg_hi:[1,0,0]
    v_pk_fma_f32 v[66:67], v[138:139], v[170:171], v[66:67] op_sel:[0,1,0] op_sel_hi:[1,1,1] neg_lo:[1,0,0] neg_hi:[1,0,0]
    v_pk_fma_f32 v[68:69], v[140:141], v[170:171], v[68:69] op_sel:[0,1,0] op_sel_hi:[1,1,1] neg_lo:[1,0,0] neg_hi:[1,0,0]
    v_pk_fma_f32 v[70:71], v[142:143], v[170:171], v[70:71] op_sel:[0,1,0] op_sel_hi:[1,1,1] neg_lo:[1,0,0] neg_hi:[1,0,0]
    v_pk_fma_f32 v[72:73], v[144:145], v[170:171], v[72:73] op_sel:[0,1,0] op_sel_hi:[1,1,1] neg_lo:[1,0,0] neg_hi:[1,0,0]
    v_pk_fma_f32 v[74:75], v[146:147], v[170:171], v[74:75] op_sel:[0,1,0] op_sel_hi:[1,1,1] neg_lo:[1,0,0] neg_hi:[1,0,0]
    v_pk_fma_f32 v[76:77], v[148:149], v[170:171], v[76:77] op_sel:[0,1,0] op_sel_hi:[1,1,1] neg_lo:[1,0,0] neg_hi:[1,0,0]
    v_pk_fma_f32 v[78:79], v[150:151], v[170:171], v[78:79] op_sel:[0,1,0] op_sel_hi:[1,1,1] neg_lo:[1,0,0] neg_hi:[1,0,0]
    v_cvt_pk_bf16_f32 v64, v64, v65
    v_cvt_pk_bf16_f32 v68, v68, v69
    v_cvt_pk_bf16_f32 v72, v72, v73
    v_cvt_pk_bf16_f32 v76, v76, v77
    v_cvt_pk_bf16_f32 v65, v66, v67
    v_cvt_pk_bf16_f32 v69, v70, v71
    v_cvt_pk_bf16_f32 v73, v74, v75
    v_cvt_pk_bf16_f32 v77, v78, v79
    ds_write_b64 v181, v[64:65] offset:0
    ds_write_b64 v181, v[68:69] offset:16
    ds_write_b64 v181, v[72:73] offset:32
    ds_write_b64 v181, v[76:77] offset:48
    v_pk_fma_f32 v[96:97], v[152:153], v[170:171], v[96:97] op_sel:[0,1,0] op_sel_hi:[1,1,1] neg_lo:[1,0,0] neg_hi:[1,0,0]
    v_pk_fma_f32 v[98:99], v[154:155], v[170:171], v[98:99] op_sel:[0,1,0] op_sel_hi:[1,1,1] neg_lo:[1,0,0] neg_hi:[1,0,0]
    v_pk_fma_f32 v[100:101], v[156:157], v[168:169], v[100:101] op_sel:[0,1,0] op_sel_hi:[1,1,1] neg_lo:[1,0,0] neg_hi:[1,0,0]
    v_pk_fma_f32 v[102:103], v[158:159], v[168:169], v[102:103] op_sel:[0,1,0] op_sel_hi:[1,1,1] neg_lo:[1,0,0] neg_hi:[1,0,0]
    v_pk_fma_f32 v[104:105], v[160:161], v[168:169], v[104:105] op_sel:[0,1,0] op_sel_hi:[1,1,1] neg_lo:[1,0,0] neg_hi:[1,0,0]
    v_pk_fma_f32 v[106:107], v[162:163], v[168:169], v[106:107] op_sel:[0,1,0] op_sel_hi:[1,1,1] neg_lo:[1,0,0] neg_hi:[1,0,0]
    v_pk_fma_f32 v[108:109], v[164:165], v[168:169], v[108:109] op_sel:[0,1,0] op_sel_hi:[1,1,1] neg_lo:[1,0,0] neg_hi:[1,0,0]
    v_pk_fma_f32 v[110:111], v[166:167], v[168:169], v[110:111] op_sel:[0,1,0] op_sel_hi:[1,1,1] neg_lo:[1,0,0] neg_hi:[1,0,0]
    v_cvt_pk_bf16_f32 v96, v96, v97
    v_cvt_pk_bf16_f32 v100, v100, v101
    v_cvt_pk_bf16_f32 v104, v104, v105
    v_cvt_pk_bf16_f32 v108, v108, v109
    v_cvt_pk_bf16_f32 v97, v98, v99
    v_cvt_pk_bf16_f32 v101, v102, v103
    v_cvt_pk_bf16_f32 v105, v106, v107
    v_cvt_pk_bf16_f32 v109, v110, v111
    ds_write_b64 v181, v[96:97] offset:64
    ds_write_b64 v182, v[100:101] offset:0
    ds_write_b64 v182, v[104:105] offset:16
    ds_write_b64 v182, v[108:109] offset:32
    v_pk_fma_f32 v[80:81], v[136:137], v[174:175], v[80:81] op_sel:[0,1,0] op_sel_hi:[1,1,1] neg_lo:[1,0,0] neg_hi:[1,0,0]
    v_pk_fma_f32 v[82:83], v[138:139], v[174:175], v[82:83] op_sel:[0,1,0] op_sel_hi:[1,1,1] neg_lo:[1,0,0] neg_hi:[1,0,0]
    v_pk_fma_f32 v[84:85], v[140:141], v[174:175], v[84:85] op_sel:[0,1,0] op_sel_hi:[1,1,1] neg_lo:[1,0,0] neg_hi:[1,0,0]
    v_pk_fma_f32 v[86:87], v[142:143], v[174:175], v[86:87] op_sel:[0,1,0] op_sel_hi:[1,1,1] neg_lo:[1,0,0] neg_hi:[1,0,0]
    v_pk_fma_f32 v[88:89], v[144:145], v[174:175], v[88:89] op_sel:[0,1,0] op_sel_hi:[1,1,1] neg_lo:[1,0,0] neg_hi:[1,0,0]
    v_pk_fma_f32 v[90:91], v[146:147], v[174:175], v[90:91] op_sel:[0,1,0] op_sel_hi:[1,1,1] neg_lo:[1,0,0] neg_hi:[1,0,0]
    v_pk_fma_f32 v[92:93], v[148:149], v[174:175], v[92:93] op_sel:[0,1,0] op_sel_hi:[1,1,1] neg_lo:[1,0,0] neg_hi:[1,0,0]
    v_pk_fma_f32 v[94:95], v[150:151], v[174:175], v[94:95] op_sel:[0,1,0] op_sel_hi:[1,1,1] neg_lo:[1,0,0] neg_hi:[1,0,0]
    v_cvt_pk_bf16_f32 v80, v80, v81
    v_cvt_pk_bf16_f32 v84, v84, v85
    v_cvt_pk_bf16_f32 v88, v88, v89
    v_cvt_pk_bf16_f32 v92, v92, v93
    v_cvt_pk_bf16_f32 v81, v82, v83
    v_cvt_pk_bf16_f32 v85, v86, v87
    v_cvt_pk_bf16_f32 v89, v90, v91
    v_cvt_pk_bf16_f32 v93, v94, v95
    ds_write_b64 v181, v[80:81] offset:2560
    ds_write_b64 v181, v[84:85] offset:2576
    ds_write_b64 v181, v[88:89] offset:2592
    ds_write_b64 v181, v[92:93] offset:2608
    v_pk_fma_f32 v[112:113], v[152:153], v[174:175], v[112:113] op_sel:[0,1,0] op_sel_hi:[1,1,1] neg_lo:[1,0,0] neg_hi:[1,0,0]
    v_pk_fma_f32 v[114:115], v[154:155], v[174:175], v[114:115] op_sel:[0,1,0] op_sel_hi:[1,1,1] neg_lo:[1,0,0] neg_hi:[1,0,0]
    v_pk_fma_f32 v[116:117], v[156:157], v[172:173], v[116:117] op_sel:[0,1,0] op_sel_hi:[1,1,1] neg_lo:[1,0,0] neg_hi:[1,0,0]
    v_pk_fma_f32 v[118:119], v[158:159], v[172:173], v[118:119] op_sel:[0,1,0] op_sel_hi:[1,1,1] neg_lo:[1,0,0] neg_hi:[1,0,0]
    v_pk_fma_f32 v[120:121], v[160:161], v[172:173], v[120:121] op_sel:[0,1,0] op_sel_hi:[1,1,1] neg_lo:[1,0,0] neg_hi:[1,0,0]
    v_pk_fma_f32 v[122:123], v[162:163], v[172:173], v[122:123] op_sel:[0,1,0] op_sel_hi:[1,1,1] neg_lo:[1,0,0] neg_hi:[1,0,0]
    v_pk_fma_f32 v[124:125], v[164:165], v[172:173], v[124:125] op_sel:[0,1,0] op_sel_hi:[1,1,1] neg_lo:[1,0,0] neg_hi:[1,0,0]
    v_pk_fma_f32 v[126:127], v[166:167], v[172:173], v[126:127] op_sel:[0,1,0] op_sel_hi:[1,1,1] neg_lo:[1,0,0] neg_hi:[1,0,0]
    v_cvt_pk_bf16_f32 v112, v112, v113
    v_cvt_pk_bf16_f32 v116, v116, v117
    v_cvt_pk_bf16_f32 v120, v120, v121
    v_cvt_pk_bf16_f32 v124, v124, v125
    v_cvt_pk_bf16_f32 v113, v114, v115
    v_cvt_pk_bf16_f32 v117, v118, v119
    v_cvt_pk_bf16_f32 v121, v122, v123
    v_cvt_pk_bf16_f32 v125, v126, v127
    ds_write_b64 v181, v[112:113] offset:2624
    ds_write_b64 v182, v[116:117] offset:5376
    ds_write_b64 v182, v[120:121] offset:5392
    ds_write_b64 v182, v[124:125] offset:5408
    s_waitcnt lgkmcnt(0)
    s_nop 7
    s_branch Lsele_1042
Lsel_1041:
    ds_read_b128 v[136:139], v179 offset:0
    ds_read_b128 v[140:143], v179 offset:32
    ds_read_b128 v[144:147], v179 offset:64
    ds_read_b128 v[148:151], v179 offset:96
    ds_read_b128 v[152:155], v179 offset:128
    ds_read_b128 v[156:159], v179 offset:160
    ds_read_b128 v[160:163], v179 offset:192
    ds_read_b128 v[164:167], v179 offset:224
    v_pk_mul_f32 v[64:65], v[64:65], v[168:169] op_sel_hi:[1,0]
    v_pk_mul_f32 v[66:67], v[66:67], v[168:169] op_sel_hi:[1,0]
    v_pk_mul_f32 v[68:69], v[68:69], v[168:169] op_sel_hi:[1,0]
    v_pk_mul_f32 v[70:71], v[70:71], v[168:169] op_sel_hi:[1,0]
    v_pk_mul_f32 v[72:73], v[72:73], v[168:169] op_sel_hi:[1,0]
    v_pk_mul_f32 v[74:75], v[74:75], v[168:169] op_sel_hi:[1,0]
    v_pk_mul_f32 v[76:77], v[76:77], v[168:169] op_sel_hi:[1,0]
    v_pk_mul_f32 v[78:79], v[78:79], v[168:169] op_sel_hi:[1,0]
    v_pk_mul_f32 v[96:97], v[96:97], v[168:169] op_sel_hi:[1,0]
    v_pk_mul_f32 v[98:99], v[98:99], v[168:169] op_sel_hi:[1,0]
    v_pk_mul_f32 v[100:101], v[100:101], v[168:169] op_sel_hi:[1,0]
    v_pk_mul_f32 v[102:103], v[102:103], v[168:169] op_sel_hi:[1,0]
    v_pk_mul_f32 v[104:105], v[104:105], v[168:169] op_sel_hi:[1,0]
    v_pk_mul_f32 v[106:107], v[106:107], v[168:169] op_sel_hi:[1,0]
    v_pk_mul_f32 v[80:81], v[80:81], v[172:173] op_sel_hi:[1,0]
    v_pk_mul_f32 v[82:83], v[82:83], v[172:173] op_sel_hi:[1,0]
    v_pk_mul_f32 v[84:85], v[84:85], v[172:173] op_sel_hi:[1,0]
    v_pk_mul_f32 v[86:87], v[86:87], v[172:173] op_sel_hi:[1,0]
    v_pk_mul_f32 v[88:89], v[88:89], v[172:173] op_sel_hi:[1,0]
    v_pk_mul_f32 v[90:91], v[90:91], v[172:173] op_sel_hi:[1,0]
    v_pk_mul_f32 v[92:93], v[92:93], v[172:173] op_sel_hi:[1,0]
    v_pk_mul_f32 v[94:95], v[94:95], v[172:173] op_sel_hi:[1,0]
    v_pk_mul_f32 v[112:113], v[112:113], v[172:173] op_sel_hi:[1,0]
    v_pk_mul_f32 v[114:115], v[114:115], v[172:173] op_sel_hi:[1,0]
    v_pk_mul_f32 v[116:117], v[116:117], v[172:173] op_sel_hi:[1,0]
    v_pk_mul_f32 v[118:119], v[118:119], v[172:173] op_sel_hi:[1,0]
    v_pk_mul_f32 v[120:121], v[120:121], v[172:173] op_sel_hi:[1,0]
    v_pk_mul_f32 v[122:123], v[122:123], v[172:173] op_sel_hi:[1,0]
    s_waitcnt lgkmcnt(0)
    v_pk_fma_f32 v[64:65], v[136:137], v[168:169], v[64:65] op_sel:[0,1,0] op_sel_hi:[1,1,1] neg_lo:[1,0,0] neg_hi:[1,0,0]
    v_pk_fma_f32 v[66:67], v[138:139], v[168:169], v[66:67] op_sel:[0,1,0] op_sel_hi:[1,1,1] neg_lo:[1,0,0] neg_hi:[1,0,0]
    v_pk_fma_f32 v[68:69], v[140:141], v[168:169], v[68:69] op_sel:[0,1,0] op_sel_hi:[1,1,1] neg_lo:[1,0,0] neg_hi:[1,0,0]
    v_pk_fma_f32 v[70:71], v[142:143], v[168:169], v[70:71] op_sel:[0,1,0] op_sel_hi:[1,1,1] neg_lo:[1,0,0] neg_hi:[1,0,0]
    v_pk_fma_f32 v[72:73], v[144:145], v[168:169], v[72:73] op_sel:[0,1,0] op_sel_hi:[1,1,1] neg_lo:[1,0,0] neg_hi:[1,0,0]
    v_pk_fma_f32 v[74:75], v[146:147], v[168:169], v[74:75] op_sel:[0,1,0] op_sel_hi:[1,1,1] neg_lo:[1,0,0] neg_hi:[1,0,0]
    v_pk_fma_f32 v[76:77], v[148:149], v[168:169], v[76:77] op_sel:[0,1,0] op_sel_hi:[1,1,1] neg_lo:[1,0,0] neg_hi:[1,0,0]
    v_pk_fma_f32 v[78:79], v[150:151], v[168:169], v[78:79] op_sel:[0,1,0] op_sel_hi:[1,1,1] neg_lo:[1,0,0] neg_hi:[1,0,0]
    v_cvt_pk_bf16_f32 v64, v64, v65
    v_cvt_pk_bf16_f32 v68, v68, v69
    v_cvt_pk_bf16_f32 v72, v72, v73
    v_cvt_pk_bf16_f32 v76, v76, v77
    v_cvt_pk_bf16_f32 v65, v66, v67
    v_cvt_pk_bf16_f32 v69, v70, v71
    v_cvt_pk_bf16_f32 v73, v74, v75
    v_cvt_pk_bf16_f32 v77, v78, v79
    ds_write_b64 v182, v[64:65] offset:48
    ds_write_b64 v182, v[68:69] offset:64
    ds_write_b64 v182, v[72:73] offset:80
    ds_write_b64 v182, v[76:77] offset:96
    v_pk_fma_f32 v[96:97], v[152:153], v[168:169], v[96:97] op_sel:[0,1,0] op_sel_hi:[1,1,1] neg_lo:[1,0,0] neg_hi:[1,0,0]
    v_pk_fma_f32 v[98:99], v[154:155], v[168:169], v[98:99] op_sel:[0,1,0] op_sel_hi:[1,1,1] neg_lo:[1,0,0] neg_hi:[1,0,0]
    v_pk_fma_f32 v[100:101], v[156:157], v[168:169], v[100:101] op_sel:[0,1,0] op_sel_hi:[1,1,1] neg_lo:[1,0,0] neg_hi:[1,0,0]
    v_pk_fma_f32 v[102:103], v[158:159], v[168:169], v[102:103] op_sel:[0,1,0] op_sel_hi:[1,1,1] neg_lo:[1,0,0] neg_hi:[1,0,0]
    v_pk_fma_f32 v[104:105], v[160:161], v[168:169], v[104:105] op_sel:[0,1,0] op_sel_hi:[1,1,1] neg_lo:[1,0,0] neg_hi:[1,0,0]
    v_pk_fma_f32 v[106:107], v[162:163], v[168:169], v[106:107] op_sel:[0,1,0] op_sel_hi:[1,1,1] neg_lo:[1,0,0] neg_hi:[1,0,0]
    v_cvt_pk_bf16_f32 v96, v96, v97
    v_cvt_pk_bf16_f32 v100, v100, v101
    v_cvt_pk_bf16_f32 v104, v104, v105
    v_cvt_pk_bf16_f32 v97, v98, v99
    v_cvt_pk_bf16_f32 v101, v102, v103
    v_cvt_pk_bf16_f32 v105, v106, v107
    ds_write_b64 v182, v[96:97] offset:112
    ds_write_b64 v182, v[100:101] offset:128
    ds_write_b64 v182, v[104:105] offset:144
    v_mov_b32 v108, 0x00003f80
    v_mov_b32 v109, 0
    s_mov_b32 exec_hi, 0
    ds_write_b64 v182, v[108:109] offset:160
    s_mov_b64 exec, -1
    v_pk_fma_f32 v[80:81], v[136:137], v[172:173], v[80:81] op_sel:[0,1,0] op_sel_hi:[1,1,1] neg_lo:[1,0,0] neg_hi:[1,0,0]
    v_pk_fma_f32 v[82:83], v[138:139], v[172:173], v[82:83] op_sel:[0,1,0] op_sel_hi:[1,1,1] neg_lo:[1,0,0] neg_hi:[1,0,0]
    v_pk_fma_f32 v[84:85], v[140:141], v[172:173], v[84:85] op_sel:[0,1,0] op_sel_hi:[1,1,1] neg_lo:[1,0,0] neg_hi:[1,0,0]
    v_pk_fma_f32 v[86:87], v[142:143], v[172:173], v[86:87] op_sel:[0,1,0] op_sel_hi:[1,1,1] neg_lo:[1,0,0] neg_hi:[1,0,0]
    v_pk_fma_f32 v[88:89], v[144:145], v[172:173], v[88:89] op_sel:[0,1,0] op_sel_hi:[1,1,1] neg_lo:[1,0,0] neg_hi:[1,0,0]
    v_pk_fma_f32 v[90:91], v[146:147], v[172:173], v[90:91] op_sel:[0,1,0] op_sel_hi:[1,1,1] neg_lo:[1,0,0] neg_hi:[1,0,0]
    v_pk_fma_f32 v[92:93], v[148:149], v[172:173], v[92:93] op_sel:[0,1,0] op_sel_hi:[1,1,1] neg_lo:[1,0,0] neg_hi:[1,0,0]
    v_pk_fma_f32 v[94:95], v[150:151], v[172:173], v[94:95] op_sel:[0,1,0] op_sel_hi:[1,1,1] neg_lo:[1,0,0] neg_hi:[1,0,0]
    v_cvt_pk_bf16_f32 v80, v80, v81
    v_cvt_pk_bf16_f32 v84, v84, v85
    v_cvt_pk_bf16_f32 v88, v88, v89
    v_cvt_pk_bf16_f32 v92, v92, v93
    v_cvt_pk_bf16_f32 v81, v82, v83
    v_cvt_pk_bf16_f32 v85, v86, v87
    v_cvt_pk_bf16_f32 v89, v90, v91
    v_cvt_pk_bf16_f32 v93, v94, v95
    ds_write_b64 v182, v[80:81] offset:5424
    ds_write_b64 v182, v[84:85] offset:5440
    ds_write_b64 v182, v[88:89] offset:5456
    ds_write_b64 v182, v[92:93] offset:5472
    v_pk_fma_f32 v[112:113], v[152:153], v[172:173], v[112:113] op_sel:[0,1,0] op_sel_hi:[1,1,1] neg_lo:[1,0,0] neg_hi:[1,0,0]
    v_pk_fma_f32 v[114:115], v[154:155], v[172:173], v[114:115] op_sel:[0,1,0] op_sel_hi:[1,1,1] neg_lo:[1,0,0] neg_hi:[1,0,0]
    v_pk_fma_f32 v[116:117], v[156:157], v[172:173], v[116:117] op_sel:[0,1,0] op_sel_hi:[1,1,1] neg_lo:[1,0,0] neg_hi:[1,0,0]
    v_pk_fma_f32 v[118:119], v[158:159], v[172:173], v[118:119] op_sel:[0,1,0] op_sel_hi:[1,1,1] neg_lo:[1,0,0] neg_hi:[1,0,0]
    v_pk_fma_f32 v[120:121], v[160:161], v[172:173], v[120:121] op_sel:[0,1,0] op_sel_hi:[1,1,1] neg_lo:[1,0,0] neg_hi:[1,0,0]
    v_pk_fma_f32 v[122:123], v[162:163], v[172:173], v[122:123] op_sel:[0,1,0] op_sel_hi:[1,1,1] neg_lo:[1,0,0] neg_hi:[1,0,0]
    v_cvt_pk_bf16_f32 v112, v112, v113
    v_cvt_pk_bf16_f32 v116, v116, v117
    v_cvt_pk_bf16_f32 v120, v120, v121
    v_cvt_pk_bf16_f32 v113, v114, v115
    v_cvt_pk_bf16_f32 v117, v118, v119
    v_cvt_pk_bf16_f32 v121, v122, v123
    ds_write_b64 v182, v[112:113] offset:5488
    ds_write_b64 v182, v[116:117] offset:5504
    ds_write_b64 v182, v[120:121] offset:5520
    v_mov_b32 v124, 0x00003f80
    v_mov_b32 v125, 0
    s_mov_b32 exec_hi, 0
    ds_write_b64 v182, v[124:125] offset:5536
    s_mov_b64 exec, -1
    s_waitcnt lgkmcnt(0)
    s_nop 7
Lsele_1042:
    s_barrier
    s_lshl_b32 s86, s73, 6
    s_lshl_b32 s87, s95, 5
    s_add_u32 s86, s86, s87
    v_and_b32 v200, 31, v0
    v_add_u32 v200, s86, v200
    v_lshlrev_b32 v200, 1, v200
    buffer_load_ushort v52, v200, s[56:59], 0 offen
    v_add_u32 v196, s80, v45
    v_add_u32 v197, s80, v46
    v_add_u32 v198, s80, v47
    s_barrier
    ds_read_b64_tr_b16 v[136:137], v196 offset:0
    ds_read_b64_tr_b16 v[138:139], v196 offset:512
    ds_read_b64_tr_b16 v[140:141], v197 offset:0
    ds_read_b64_tr_b16 v[142:143], v197 offset:512
    ds_read_b64_tr_b16 v[144:145], v198 offset:0
    ds_read_b64_tr_b16 v[146:147], v198 offset:512
    ds_read_b64_tr_b16 v[148:149], v196 offset:2048
    ds_read_b64_tr_b16 v[150:151], v196 offset:2560
    ds_read_b64_tr_b16 v[152:153], v197 offset:2048
    ds_read_b64_tr_b16 v[154:155], v197 offset:2560
    ds_read_b64_tr_b16 v[156:157], v198 offset:2048
    ds_read_b64_tr_b16 v[158:159], v198 offset:2560
    s_waitcnt lgkmcnt(6)
    v_mfma_f32_32x32x16_bf16 v[64:79], v[136:139], v[144:147], 0
    ds_read_b64_tr_b16 v[160:161], v196 offset:4096
    ds_read_b64_tr_b16 v[162:163], v196 offset:4608
    ds_read_b64_tr_b16 v[164:165], v197 offset:4096
    v_mfma_f32_32x32x16_bf16 v[80:95], v[140:143], v[144:147], 0
    ds_read_b64_tr_b16 v[166:167], v197 offset:4608
    ds_read_b64_tr_b16 v[168:169], v198 offset:4096
    ds_read_b64_tr_b16 v[170:171], v198 offset:4608
    s_waitcnt lgkmcnt(6)
    v_mfma_f32_32x32x16_bf16 v[64:79], v[148:151], v[156:159], v[64:79]
    ds_read_b64_tr_b16 v[172:173], v196 offset:6144
    ds_read_b64_tr_b16 v[174:175], v196 offset:6656
    ds_read_b64_tr_b16 v[176:177], v197 offset:6144
    v_mfma_f32_32x32x16_bf16 v[80:95], v[152:155], v[156:159], v[80:95]
    ds_read_b64_tr_b16 v[178:179], v197 offset:6656
    ds_read_b64_tr_b16 v[180:181], v198 offset:6144
    ds_read_b64_tr_b16 v[182:183], v198 offset:6656
    s_add_u32 s80, s80, 36864
    s_cmp_eq_u32 s80, 147456
    s_cselect_b32 s80, 0, s80
    v_add_u32 v196, s80, v45
    v_add_u32 v197, s80, v46
    v_add_u32 v198, s80, v47
    s_waitcnt lgkmcnt(0)
    v_mov_b32 v223, 0
    v_mov_b32 v222, 0
    v_mov_b32 v221, 0
    v_mov_b32 v220, 0
    v_mov_b32 v219, 0
    v_mov_b32 v218, 0
    v_mov_b32 v217, 0
    v_mov_b32 v216, 0
    v_mov_b32 v215, 0
    v_mov_b32 v214, 0
    v_mov_b32 v213, 0
    v_mov_b32 v212, 0
    v_mov_b32 v211, 0
    v_mov_b32 v210, 0
    v_mov_b32 v209, 0
    v_mov_b32 v208, 0
    s_barrier
    v_mfma_f32_32x32x16_bf16 v[64:79], v[160:163], v[168:171], v[64:79]
    ds_read_b64_tr_b16 v[136:137], v196 offset:0
    ds_read_b64_tr_b16 v[138:139], v196 offset:512
    ds_read_b64_tr_b16 v[140:141], v197 offset:0
    v_mfma_f32_32x32x16_bf16 v[80:95], v[164:167], v[168:171], v[80:95]
    ds_read_b64_tr_b16 v[142:143], v197 offset:512
    ds_read_b64_tr_b16 v[144:145], v198 offset:0
    ds_read_b64_tr_b16 v[146:147], v198 offset:512
    v_mfma_f32_32x32x16_bf16 v[64:79], v[172:175], v[180:183], v[64:79]
    ds_read_b64_tr_b16 v[148:149], v196 offset:2048
    ds_read_b64_tr_b16 v[150:151], v196 offset:2560
    ds_read_b64_tr_b16 v[152:153], v197 offset:2048
    v_mfma_f32_32x32x16_bf16 v[80:95], v[176:179], v[180:183], v[80:95]
    ds_read_b64_tr_b16 v[154:155], v197 offset:2560
    ds_read_b64_tr_b16 v[156:157], v198 offset:2048
    ds_read_b64_tr_b16 v[158:159], v198 offset:2560
    s_waitcnt lgkmcnt(6)
    v_mfma_f32_32x32x16_bf16 v[64:79], v[136:139], v[144:147], v[64:79]
    ds_read_b64_tr_b16 v[160:161], v196 offset:4096
    ds_read_b64_tr_b16 v[162:163], v196 offset:4608
    ds_read_b64_tr_b16 v[164:165], v197 offset:4096
    v_mfma_f32_32x32x16_bf16 v[80:95], v[140:143], v[144:147], v[80:95]
    ds_read_b64_tr_b16 v[166:167], v197 offset:4608
    ds_read_b64_tr_b16 v[168:169], v198 offset:4096
    ds_read_b64_tr_b16 v[170:171], v198 offset:4608
    s_waitcnt lgkmcnt(6)
    v_mfma_f32_32x32x16_bf16 v[64:79], v[148:151], v[156:159], v[64:79]
    ds_read_b64_tr_b16 v[172:173], v196 offset:6144
    ds_read_b64_tr_b16 v[174:175], v196 offset:6656
    ds_read_b64_tr_b16 v[176:177], v197 offset:6144
    v_mfma_f32_32x32x16_bf16 v[80:95], v[152:155], v[156:159], v[80:95]
    ds_read_b64_tr_b16 v[178:179], v197 offset:6656
    ds_read_b64_tr_b16 v[180:181], v198 offset:6144
    ds_read_b64_tr_b16 v[182:183], v198 offset:6656
    s_add_u32 s80, s80, 36864
    s_cmp_eq_u32 s80, 147456
    s_cselect_b32 s80, 0, s80
    v_add_u32 v196, s80, v45
    v_add_u32 v197, s80, v46
    v_add_u32 v198, s80, v47
    s_waitcnt lgkmcnt(0)
    v_mov_b32 v239, 0
    v_mov_b32 v238, 0
    v_mov_b32 v237, 0
    v_mov_b32 v236, 0
    v_mov_b32 v235, 0
    v_mov_b32 v234, 0
    v_mov_b32 v233, 0
    v_mov_b32 v232, 0
    v_mov_b32 v231, 0
    v_mov_b32 v230, 0
    v_mov_b32 v229, 0
    v_mov_b32 v228, 0
    v_mov_b32 v227, 0
    v_mov_b32 v226, 0
    v_mov_b32 v225, 0
    v_mov_b32 v224, 0
    s_barrier
    v_mfma_f32_32x32x16_bf16 v[64:79], v[160:163], v[168:171], v[64:79]
    ds_read_b64_tr_b16 v[136:137], v196 offset:0
    ds_read_b64_tr_b16 v[138:139], v196 offset:512
    ds_read_b64_tr_b16 v[140:141], v197 offset:0
    v_mfma_f32_32x32x16_bf16 v[80:95], v[164:167], v[168:171], v[80:95]
    ds_read_b64_tr_b16 v[142:143], v197 offset:512
    ds_read_b64_tr_b16 v[144:145], v198 offset:0
    ds_read_b64_tr_b16 v[146:147], v198 offset:512
    v_mfma_f32_32x32x16_bf16 v[64:79], v[172:175], v[180:183], v[64:79]
    ds_read_b64_tr_b16 v[148:149], v196 offset:2048
    ds_read_b64_tr_b16 v[150:151], v196 offset:2560
    ds_read_b64_tr_b16 v[152:153], v197 offset:2048
    v_mfma_f32_32x32x16_bf16 v[80:95], v[176:179], v[180:183], v[80:95]
    ds_read_b64_tr_b16 v[154:155], v197 offset:2560
    ds_read_b64_tr_b16 v[156:157], v198 offset:2048
    ds_read_b64_tr_b16 v[158:159], v198 offset:2560
    s_waitcnt lgkmcnt(6)
    v_mfma_f32_32x32x16_bf16 v[64:79], v[136:139], v[144:147], v[64:79]
    ds_read_b64_tr_b16 v[160:161], v196 offset:4096
    ds_read_b64_tr_b16 v[162:163], v196 offset:4608
    ds_read_b64_tr_b16 v[164:165], v197 offset:4096
    v_mfma_f32_32x32x16_bf16 v[80:95], v[140:143], v[144:147], v[80:95]
    ds_read_b64_tr_b16 v[166:167], v197 offset:4608
    ds_read_b64_tr_b16 v[168:169], v198 offset:4096
    ds_read_b64_tr_b16 v[170:171], v198 offset:4608
    s_waitcnt lgkmcnt(6)
    v_mfma_f32_32x32x16_bf16 v[64:79], v[148:151], v[156:159], v[64:79]
    ds_read_b64_tr_b16 v[172:173], v196 offset:6144
    ds_read_b64_tr_b16 v[174:175], v196 offset:6656
    ds_read_b64_tr_b16 v[176:177], v197 offset:6144
    v_mfma_f32_32x32x16_bf16 v[80:95], v[152:155], v[156:159], v[80:95]
    ds_read_b64_tr_b16 v[178:179], v197 offset:6656
    ds_read_b64_tr_b16 v[180:181], v198 offset:6144
    ds_read_b64_tr_b16 v[182:183], v198 offset:6656
    s_add_u32 s80, s80, 36864
    s_cmp_eq_u32 s80, 147456
    s_cselect_b32 s80, 0, s80
    v_add_u32 v196, s80, v45
    v_add_u32 v197, s80, v46
    v_add_u32 v198, s80, v47
    s_waitcnt lgkmcnt(0)
    s_mov_b32 s81, 13
Lloop_1043:
    s_barrier
    v_mfma_f32_32x32x16_bf16 v[64:79], v[160:163], v[168:171], v[64:79]
    ds_read_b64_tr_b16 v[136:137], v196 offset:0
    ds_read_b64_tr_b16 v[138:139], v196 offset:512
    ds_read_b64_tr_b16 v[140:141], v197 offset:0
    v_mfma_f32_32x32x16_bf16 v[80:95], v[164:167], v[168:171], v[80:95]
    ds_read_b64_tr_b16 v[142:143], v197 offset:512
    ds_read_b64_tr_b16 v[144:145], v198 offset:0
    ds_read_b64_tr_b16 v[146:147], v198 offset:512
    v_mfma_f32_32x32x16_bf16 v[64:79], v[172:175], v[180:183], v[64:79]
    ds_read_b64_tr_b16 v[148:149], v196 offset:2048
    ds_read_b64_tr_b16 v[150:151], v196 offset:2560
    ds_read_b64_tr_b16 v[152:153], v197 offset:2048
    v_mfma_f32_32x32x16_bf16 v[80:95], v[176:179], v[180:183], v[80:95]
    ds_read_b64_tr_b16 v[154:155], v197 offset:2560
    ds_read_b64_tr_b16 v[156:157], v198 offset:2048
    ds_read_b64_tr_b16 v[158:159], v198 offset:2560
    s_waitcnt lgkmcnt(6)
    v_mfma_f32_32x32x16_bf16 v[64:79], v[136:139], v[144:147], v[64:79]
    ds_read_b64_tr_b16 v[160:161], v196 offset:4096
    ds_read_b64_tr_b16 v[162:163], v196 offset:4608
    ds_read_b64_tr_b16 v[164:165], v197 offset:4096
    v_mfma_f32_32x32x16_bf16 v[80:95], v[140:143], v[144:147], v[80:95]
    ds_read_b64_tr_b16 v[166:167], v197 offset:4608
    ds_read_b64_tr_b16 v[168:169], v198 offset:4096
    ds_read_b64_tr_b16 v[170:171], v198 offset:4608
    s_waitcnt lgkmcnt(6)
    v_mfma_f32_32x32x16_bf16 v[64:79], v[148:151], v[156:159], v[64:79]
    ds_read_b64_tr_b16 v[172:173], v196 offset:6144
    ds_read_b64_tr_b16 v[174:175], v196 offset:6656
    ds_read_b64_tr_b16 v[176:177], v197 offset:6144
    v_mfma_f32_32x32x16_bf16 v[80:95], v[152:155], v[156:159], v[80:95]
    ds_read_b64_tr_b16 v[178:179], v197 offset:6656
    ds_read_b64_tr_b16 v[180:181], v198 offset:6144
    ds_read_b64_tr_b16 v[182:183], v198 offset:6656
    s_add_u32 s80, s80, 36864
    s_cmp_eq_u32 s80, 147456
    s_cselect_b32 s80, 0, s80
    v_add_u32 v196, s80, v45
    v_add_u32 v197, s80, v46
    v_add_u32 v198, s80, v47
    s_waitcnt lgkmcnt(0)
    s_sub_u32 s81, s81, 1
    s_cmp_lg_u32 s81, 0
    s_cbranch_scc1 Lloop_1043
    v_mfma_f32_32x32x16_bf16 v[64:79], v[160:163], v[168:171], v[64:79]
    v_mfma_f32_32x32x16_bf16 v[80:95], v[164:167], v[168:171], v[80:95]
    v_mfma_f32_32x32x16_bf16 v[64:79], v[172:175], v[180:183], v[64:79]
    v_mfma_f32_32x32x16_bf16 v[80:95], v[176:179], v[180:183], v[80:95]
    s_lshl_b32 s87, s95, 5
    v_and_b32 v200, 31, v0
    v_add_u32 v200, s87, v200
    v_mul_u32_u24 v200, 144, v200
    v_lshrrev_b32 v201, 5, v0
    v_lshl_add_u32 v200, v201, 3, v200
    s_lshl_b32 s87, s94, 6
    s_add_u32 s87, s87, 36864
    v_add_u32 v200, s87, v200
    v_lshlrev_b32 v201, 4, v0
    s_xor_b32 s86, s69, 2
    s_lshl_b32 s86, s86, 12
    s_add_u32 s86, s86, 16384
    v_add_u32 v201, s86, v201
    v_mov_b32 v204, 0xbdd2d3e8
    v_mov_b32 v205, 0xc0135761
    v_mov_b32 v206, 1.0
    s_waitcnt vmcnt(0)
    v_lshlrev_b32 v202, 16, v52
    v_lshlrev_b32 v190, 4, v0
    s_lshl_b32 s86, s69, 12
    s_add_u32 s86, s86, 16384
    v_add_u32 v190, s86, v190
    ds_write_b128 v190, v[80:83] offset:0
    ds_write_b128 v190, v[84:87] offset:1024
    ds_write_b128 v190, v[88:91] offset:2048
    ds_write_b128 v190, v[92:95] offset:3072
    s_waitcnt lgkmcnt(0)
    s_barrier
    ds_read_b128 v[136:139], v201 offset:0
    ds_read_b128 v[140:143], v201 offset:1024
    ds_read_b128 v[144:147], v201 offset:2048
    ds_read_b128 v[148:151], v201 offset:3072
    v_pk_add_f32 v[64:65], v[64:65], v[202:203] op_sel_hi:[1,0]
    v_pk_add_f32 v[66:67], v[66:67], v[202:203] op_sel_hi:[1,0]
    v_pk_add_f32 v[68:69], v[68:69], v[202:203] op_sel_hi:[1,0]
    v_pk_add_f32 v[70:71], v[70:71], v[202:203] op_sel_hi:[1,0]
    v_pk_add_f32 v[72:73], v[72:73], v[202:203] op_sel_hi:[1,0]
    v_pk_add_f32 v[74:75], v[74:75], v[202:203] op_sel_hi:[1,0]
    v_pk_add_f32 v[76:77], v[76:77], v[202:203] op_sel_hi:[1,0]
    v_pk_add_f32 v[78:79], v[78:79], v[202:203] op_sel_hi:[1,0]
    s_waitcnt lgkmcnt(0)
    v_pk_add_f32 v[64:65], v[64:65], v[136:137]
    v_pk_add_f32 v[66:67], v[66:67], v[138:139]
    v_pk_add_f32 v[68:69], v[68:69], v[140:141]
    v_pk_add_f32 v[70:71], v[70:71], v[142:143]
    v_pk_add_f32 v[72:73], v[72:73], v[144:145]
    v_pk_add_f32 v[74:75], v[74:75], v[146:147]
    v_pk_add_f32 v[76:77], v[76:77], v[148:149]
    v_pk_add_f32 v[78:79], v[78:79], v[150:151]
    v_pk_mul_f32 v[136:137], v[64:65], v[64:65]
    v_pk_mul_f32 v[138:139], v[66:67], v[66:67]
    v_pk_mul_f32 v[140:141], v[68:69], v[68:69]
    v_pk_mul_f32 v[142:143], v[70:71], v[70:71]
    v_pk_mul_f32 v[144:145], v[72:73], v[72:73]
    v_pk_mul_f32 v[146:147], v[74:75], v[74:75]
    v_pk_mul_f32 v[148:149], v[76:77], v[76:77]
    v_pk_mul_f32 v[150:151], v[78:79], v[78:79]
    v_pk_fma_f32 v[136:137], v[136:137], v[204:205], v[204:205] op_sel:[0,0,1] op_sel_hi:[1,0,1]
    v_pk_fma_f32 v[138:139], v[138:139], v[204:205], v[204:205] op_sel:[0,0,1] op_sel_hi:[1,0,1]
    v_pk_fma_f32 v[140:141], v[140:141], v[204:205], v[204:205] op_sel:[0,0,1] op_sel_hi:[1,0,1]
    v_pk_fma_f32 v[142:143], v[142:143], v[204:205], v[204:205] op_sel:[0,0,1] op_sel_hi:[1,0,1]
    v_pk_fma_f32 v[144:145], v[144:145], v[204:205], v[204:205] op_sel:[0,0,1] op_sel_hi:[1,0,1]
    v_pk_fma_f32 v[146:147], v[146:147], v[204:205], v[204:205] op_sel:[0,0,1] op_sel_hi:[1,0,1]
    v_pk_fma_f32 v[148:149], v[148:149], v[204:205], v[204:205] op_sel:[0,0,1] op_sel_hi:[1,0,1]
    v_pk_fma_f32 v[150:151], v[150:151], v[204:205], v[204:205] op_sel:[0,0,1] op_sel_hi:[1,0,1]
    v_pk_mul_f32 v[136:137], v[136:137], v[64:65]
    v_pk_mul_f32 v[138:139], v[138:139], v[66:67]
    v_pk_mul_f32 v[140:141], v[140:141], v[68:69]
    v_pk_mul_f32 v[142:143], v[142:143], v[70:71]
    v_pk_mul_f32 v[144:145], v[144:145], v[72:73]
    v_pk_mul_f32 v[146:147], v[146:147], v[74:75]
    v_pk_mul_f32 v[148:149], v[148:149], v[76:77]
    v_pk_mul_f32 v[150:151], v[150:151], v[78:79]
    v_exp_f32 v136, v136
    v_exp_f32 v137, v137
    v_exp_f32 v138, v138
    v_exp_f32 v139, v139
    v_exp_f32 v140, v140
    v_exp_f32 v141, v141
    v_exp_f32 v142, v142
    v_exp_f32 v143, v143
    v_exp_f32 v144, v144
    v_exp_f32 v145, v145
    v_exp_f32 v146, v146
    v_exp_f32 v147, v147
    v_exp_f32 v148, v148
    v_exp_f32 v149, v149
    v_exp_f32 v150, v150
    v_exp_f32 v151, v151
    v_pk_add_f32 v[136:137], v[136:137], v[206:207] op_sel_hi:[1,0]
    v_pk_add_f32 v[138:139], v[138:139], v[206:207] op_sel_hi:[1,0]
    v_pk_add_f32 v[140:141], v[140:141], v[206:207] op_sel_hi:[1,0]
    v_pk_add_f32 v[142:143], v[142:143], v[206:207] op_sel_hi:[1,0]
    v_pk_add_f32 v[144:145], v[144:145], v[206:207] op_sel_hi:[1,0]
    v_pk_add_f32 v[146:147], v[146:147], v[206:207] op_sel_hi:[1,0]
    v_pk_add_f32 v[148:149], v[148:149], v[206:207] op_sel_hi:[1,0]
    v_pk_add_f32 v[150:151], v[150:151], v[206:207] op_sel_hi:[1,0]
    v_rcp_f32 v136, v136
    v_rcp_f32 v137, v137
    v_rcp_f32 v138, v138
    v_rcp_f32 v139, v139
    v_rcp_f32 v140, v140
    v_rcp_f32 v141, v141
    v_rcp_f32 v142, v142
    v_rcp_f32 v143, v143
    v_rcp_f32 v144, v144
    v_rcp_f32 v145, v145
    v_rcp_f32 v146, v146
    v_rcp_f32 v147, v147
    v_rcp_f32 v148, v148
    v_rcp_f32 v149, v149
    v_rcp_f32 v150, v150
    v_rcp_f32 v151, v151
    v_pk_mul_f32 v[64:65], v[64:65], v[136:137]
    v_pk_mul_f32 v[66:67], v[66:67], v[138:139]
    v_pk_mul_f32 v[68:69], v[68:69], v[140:141]
    v_pk_mul_f32 v[70:71], v[70:71], v[142:143]
    v_pk_mul_f32 v[72:73], v[72:73], v[144:145]
    v_pk_mul_f32 v[74:75], v[74:75], v[146:147]
    v_pk_mul_f32 v[76:77], v[76:77], v[148:149]
    v_pk_mul_f32 v[78:79], v[78:79], v[150:151]
    v_cvt_pk_bf16_f32 v64, v64, v65
    v_cvt_pk_bf16_f32 v65, v66, v67
    ds_write_b64 v200, v[64:65] offset:0
    v_cvt_pk_bf16_f32 v68, v68, v69
    v_cvt_pk_bf16_f32 v69, v70, v71
    ds_write_b64 v200, v[68:69] offset:16
    v_cvt_pk_bf16_f32 v72, v72, v73
    v_cvt_pk_bf16_f32 v73, v74, v75
    ds_write_b64 v200, v[72:73] offset:32
    v_cvt_pk_bf16_f32 v76, v76, v77
    v_cvt_pk_bf16_f32 v77, v78, v79
    ds_write_b64 v200, v[76:77] offset:48
    s_waitcnt lgkmcnt(0)
    v_mov_b32 v86, 0
    v_mov_b32 v87, 0
    v_mov_b32 v70, 0
    v_mov_b32 v71, 0
    v_mov_b32 v94, 0
    v_mov_b32 v95, 0
    v_mov_b32 v78, 0
    v_mov_b32 v79, 0
    s_barrier
    s_lshl_b32 s86, s70, 2
    s_add_u32 s86, s86, s69
    s_cmp_ge_u32 s86, 8
    s_cselect_b32 s86, 8, s86
    s_sub_u32 s88, 8, s86
    s_mul_i32 s87, s88, 5376
    v_add_u32 v34, s87, v34
    v_add_u32 v35, s87, v35
    v_add_u32 v36, s87, v36
    v_add_u32 v37, s87, v37
    s_lshl_b32 s86, s69, 5
    v_and_b32 v192, 31, v0
    v_add_u32 v192, s86, v192
    v_mul_u32_u24 v192, 80, v192
    v_add_u32 v192, 147456, v192
    v_lshrrev_b32 v193, 5, v0
    v_lshl_add_u32 v193, v193, 4, v192
    ds_read_b64 v[64:65], v193 offset:0
    ds_read_b64 v[66:67], v193 offset:8
    ds_read_b64 v[68:69], v192 offset:32
    ds_read_b64 v[72:73], v193 offset:40
    ds_read_b64 v[74:75], v193 offset:48
    ds_read_b64 v[76:77], v192 offset:72
    ds_read_b64 v[80:81], v34 offset:0
    ds_read_b64 v[82:83], v34 offset:8
    ds_read_b64 v[84:85], v35 offset:32
    ds_read_b64 v[88:89], v34 offset:40
    ds_read_b64 v[90:91], v34 offset:48
    ds_read_b64 v[92:93], v35 offset:72
    s_waitcnt lgkmcnt(0)
    s_mov_b32 exec_lo, 0
    v_mov_b32 v68, 0
    v_mov_b32 v69, 0
    s_mov_b64 exec, -1
    s_mov_b32 exec_lo, 0
    v_mov_b32 v76, 0
    v_mov_b32 v77, 0
    s_mov_b64 exec, -1
    s_cmp_lg_u32 s88, 0
    s_cbranch_scc1 Larare_1051
    v_mfma_f32_32x32x16_bf16 v[112:127], v[80:83], v[64:67], v[2:17]
    v_mfma_f32_32x32x16_bf16 v[112:127], v[84:87], v[68:71], v[112:127]
    ds_read_b64 v[80:81], v34 offset:5376
    ds_read_b64 v[82:83], v34 offset:5384
    ds_read_b64 v[84:85], v35 offset:5408
    ds_read_b64_tr_b16 v[96:97], v36 offset:0
    ds_read_b64_tr_b16 v[98:99], v36 offset:1344
    ds_read_b64_tr_b16 v[100:101], v36 offset:2688
    ds_read_b64_tr_b16 v[102:103], v36 offset:4032
    s_waitcnt lgkmcnt(7)
    v_mfma_f32_32x32x16_bf16 v[128:143], v[88:91], v[72:75], v[2:17]
    ds_read_b64 v[88:89], v34 offset:5416
    ds_read_b64 v[90:91], v34 offset:5424
    s_nop 0
    v_exp_f32 v112, v112
    v_exp_f32 v113, v113
    v_exp_f32 v114, v114
    v_exp_f32 v115, v115
    v_mfma_f32_32x32x16_bf16 v[128:143], v[92:95], v[76:79], v[128:143]
    ds_read_b64 v[92:93], v35 offset:5448
    v_exp_f32 v116, v116
    v_exp_f32 v117, v117
    v_exp_f32 v118, v118
    v_exp_f32 v119, v119
    ds_read_b64_tr_b16 v[104:105], v37 offset:0
    ds_read_b64_tr_b16 v[106:107], v37 offset:1344
    v_exp_f32 v120, v120
    v_exp_f32 v121, v121
    v_exp_f32 v122, v122
    v_exp_f32 v123, v123
    ds_read_b64_tr_b16 v[108:109], v37 offset:2688
    ds_read_b64_tr_b16 v[110:111], v37 offset:4032
    v_exp_f32 v124, v124
    v_exp_f32 v125, v125
    v_exp_f32 v126, v126
    v_exp_f32 v127, v127
    v_cvt_pk_bf16_f32 v144, v112, v113
    v_cvt_pk_bf16_f32 v145, v114, v115
    v_cvt_pk_bf16_f32 v146, v116, v117
    v_cvt_pk_bf16_f32 v147, v118, v119
    v_cvt_pk_bf16_f32 v148, v120, v121
    v_cvt_pk_bf16_f32 v149, v122, v123
    v_cvt_pk_bf16_f32 v150, v124, v125
    v_cvt_pk_bf16_f32 v151, v126, v127
    s_waitcnt lgkmcnt(7)
    v_mfma_f32_32x32x16_bf16 v[112:127], v[80:83], v[64:67], 0
    ds_read_b64 v[80:81], v34 offset:10752
    ds_read_b64 v[82:83], v34 offset:10760
    v_exp_f32 v128, v128
    v_exp_f32 v129, v129
    v_exp_f32 v130, v130
    v_exp_f32 v131, v131
    v_mfma_f32_32x32x16_bf16 v[112:127], v[84:87], v[68:71], v[112:127]
    ds_read_b64 v[84:85], v35 offset:10784
    v_exp_f32 v132, v132
    v_exp_f32 v133, v133
    v_exp_f32 v134, v134
    v_exp_f32 v135, v135
    v_mfma_f32_32x32x16_bf16 v[208:223], v[96:99], v[144:147], v[208:223]
    ds_read_b64_tr_b16 v[96:97], v36 offset:5376
    ds_read_b64_tr_b16 v[98:99], v36 offset:6720
    v_exp_f32 v136, v136
    v_exp_f32 v137, v137
    v_exp_f32 v138, v138
    v_exp_f32 v139, v139
    v_mfma_f32_32x32x16_bf16 v[208:223], v[100:103], v[148:151], v[208:223]
    ds_read_b64_tr_b16 v[100:101], v36 offset:8064
    ds_read_b64_tr_b16 v[102:103], v36 offset:9408
    v_exp_f32 v140, v140
    v_exp_f32 v141, v141
    v_exp_f32 v142, v142
    v_exp_f32 v143, v143
    v_cvt_pk_bf16_f32 v152, v128, v129
    v_cvt_pk_bf16_f32 v153, v130, v131
    v_cvt_pk_bf16_f32 v154, v132, v133
    v_cvt_pk_bf16_f32 v155, v134, v135
    v_cvt_pk_bf16_f32 v156, v136, v137
    v_cvt_pk_bf16_f32 v157, v138, v139
    v_cvt_pk_bf16_f32 v158, v140, v141
    v_cvt_pk_bf16_f32 v159, v142, v143
    v_add_u32 v34, 5376, v34
    v_add_u32 v35, 5376, v35
    v_add_u32 v36, 5376, v36
    v_add_u32 v37, 5376, v37
    s_mov_b32 s81, 6
Lamid_1047:
    s_waitcnt lgkmcnt(7)
    v_mfma_f32_32x32x16_bf16 v[128:143], v[88:91], v[72:75], 0
    ds_read_b64 v[88:89], v34 offset:5416
    ds_read_b64 v[90:91], v34 offset:5424
    v_exp_f32 v112, v112
    v_exp_f32 v113, v113
    v_exp_f32 v114, v114
    v_exp_f32 v115, v115
    v_mfma_f32_32x32x16_bf16 v[128:143], v[92:95], v[76:79], v[128:143]
    ds_read_b64 v[92:93], v35 offset:5448
    v_exp_f32 v116, v116
    v_exp_f32 v117, v117
    v_exp_f32 v118, v118
    v_exp_f32 v119, v119
    v_mfma_f32_32x32x16_bf16 v[224:239], v[104:107], v[152:155], v[224:239]
    ds_read_b64_tr_b16 v[104:105], v37 offset:0
    ds_read_b64_tr_b16 v[106:107], v37 offset:1344
    v_exp_f32 v120, v120
    v_exp_f32 v121, v121
    v_exp_f32 v122, v122
    v_exp_f32 v123, v123
    v_mfma_f32_32x32x16_bf16 v[224:239], v[108:111], v[156:159], v[224:239]
    ds_read_b64_tr_b16 v[108:109], v37 offset:2688
    ds_read_b64_tr_b16 v[110:111], v37 offset:4032
    v_exp_f32 v124, v124
    v_exp_f32 v125, v125
    v_exp_f32 v126, v126
    v_exp_f32 v127, v127
    v_cvt_pk_bf16_f32 v144, v112, v113
    v_cvt_pk_bf16_f32 v145, v114, v115
    v_cvt_pk_bf16_f32 v146, v116, v117
    v_cvt_pk_bf16_f32 v147, v118, v119
    v_cvt_pk_bf16_f32 v148, v120, v121
    v_cvt_pk_bf16_f32 v149, v122, v123
    v_cvt_pk_bf16_f32 v150, v124, v125
    v_cvt_pk_bf16_f32 v151, v126, v127
    s_waitcnt lgkmcnt(7)
    v_mfma_f32_32x32x16_bf16 v[112:127], v[80:83], v[64:67], 0
    ds_read_b64 v[80:81], v34 offset:10752
    ds_read_b64 v[82:83], v34 offset:10760
    v_exp_f32 v128, v128
    v_exp_f32 v129, v129
    v_exp_f32 v130, v130
    v_exp_f32 v131, v131
    v_mfma_f32_32x32x16_bf16 v[112:127], v[84:87], v[68:71], v[112:127]
    ds_read_b64 v[84:85], v35 offset:10784
    v_exp_f32 v132, v132
    v_exp_f32 v133, v133
    v_exp_f32 v134, v134
    v_exp_f32 v135, v135
    v_mfma_f32_32x32x16_bf16 v[208:223], v[96:99], v[144:147], v[208:223]
    ds_read_b64_tr_b16 v[96:97], v36 offset:5376
    ds_read_b64_tr_b16 v[98:99], v36 offset:6720
    v_exp_f32 v136, v136
    v_exp_f32 v137, v137
    v_exp_f32 v138, v138
    v_exp_f32 v139, v139
    v_mfma_f32_32x32x16_bf16 v[208:223], v[100:103], v[148:151], v[208:223]
    ds_read_b64_tr_b16 v[100:101], v36 offset:8064
    ds_read_b64_tr_b16 v[102:103], v36 offset:9408
    v_exp_f32 v140, v140
    v_exp_f32 v141, v141
    v_exp_f32 v142, v142
    v_exp_f32 v143, v143
    v_cvt_pk_bf16_f32 v152, v128, v129
    v_cvt_pk_bf16_f32 v153, v130, v131
    v_cvt_pk_bf16_f32 v154, v132, v133
    v_cvt_pk_bf16_f32 v155, v134, v135
    v_cvt_pk_bf16_f32 v156, v136, v137
    v_cvt_pk_bf16_f32 v157, v138, v139
    v_cvt_pk_bf16_f32 v158, v140, v141
    v_cvt_pk_bf16_f32 v159, v142, v143
    v_add_u32 v34, 5376, v34
    v_add_u32 v35, 5376, v35
    v_add_u32 v36, 5376, v36
    v_add_u32 v37, 5376, v37
    s_sub_u32 s81, s81, 1
    s_cmp_lg_u32 s81, 0
    s_cbranch_scc1 Lamid_1047
Lapre_1048:
    s_waitcnt lgkmcnt(7)
    v_mfma_f32_32x32x16_bf16 v[128:143], v[88:91], v[72:75], 0
    ds_read_b64 v[88:89], v34 offset:5416
    ds_read_b64 v[90:91], v34 offset:5424
    v_exp_f32 v112, v112
    v_exp_f32 v113, v113
    v_exp_f32 v114, v114
    v_exp_f32 v115, v115
    v_mfma_f32_32x32x16_bf16 v[128:143], v[92:95], v[76:79], v[128:143]
    ds_read_b64 v[92:93], v35 offset:5448
    v_exp_f32 v116, v116
    v_exp_f32 v117, v117
    v_exp_f32 v118, v118
    v_exp_f32 v119, v119
    v_mfma_f32_32x32x16_bf16 v[224:239], v[104:107], v[152:155], v[224:239]
    ds_read_b64_tr_b16 v[104:105], v37 offset:0
    ds_read_b64_tr_b16 v[106:107], v37 offset:1344
    v_exp_f32 v120, v120
    v_exp_f32 v121, v121
    v_exp_f32 v122, v122
    v_exp_f32 v123, v123
    v_mfma_f32_32x32x16_bf16 v[224:239], v[108:111], v[156:159], v[224:239]
    ds_read_b64_tr_b16 v[108:109], v37 offset:2688
    ds_read_b64_tr_b16 v[110:111], v37 offset:4032
    v_exp_f32 v124, v124
    v_exp_f32 v125, v125
    v_exp_f32 v126, v126
    v_exp_f32 v127, v127
    v_cvt_pk_bf16_f32 v144, v112, v113
    v_cvt_pk_bf16_f32 v145, v114, v115
    v_cvt_pk_bf16_f32 v146, v116, v117
    v_cvt_pk_bf16_f32 v147, v118, v119
    v_cvt_pk_bf16_f32 v148, v120, v121
    v_cvt_pk_bf16_f32 v149, v122, v123
    v_cvt_pk_bf16_f32 v150, v124, v125
    v_cvt_pk_bf16_f32 v151, v126, v127
    s_waitcnt lgkmcnt(7)
    v_mfma_f32_32x32x16_bf16 v[112:127], v[80:83], v[64:67], v[18:33]
    ds_read_b64 v[80:81], v34 offset:10752
    ds_read_b64 v[82:83], v34 offset:10760
    v_exp_f32 v128, v128
    v_exp_f32 v129, v129
    v_exp_f32 v130, v130
    v_exp_f32 v131, v131
    v_mfma_f32_32x32x16_bf16 v[112:127], v[84:87], v[68:71], v[112:127]
    ds_read_b64 v[84:85], v35 offset:10784
    v_exp_f32 v132, v132
    v_exp_f32 v133, v133
    v_exp_f32 v134, v134
    v_exp_f32 v135, v135
    v_mfma_f32_32x32x16_bf16 v[208:223], v[96:99], v[144:147], v[208:223]
    ds_read_b64_tr_b16 v[96:97], v36 offset:5376
    ds_read_b64_tr_b16 v[98:99], v36 offset:6720
    v_exp_f32 v136, v136
    v_exp_f32 v137, v137
    v_exp_f32 v138, v138
    v_exp_f32 v139, v139
    v_mfma_f32_32x32x16_bf16 v[208:223], v[100:103], v[148:151], v[208:223]
    ds_read_b64_tr_b16 v[100:101], v36 offset:8064
    ds_read_b64_tr_b16 v[102:103], v36 offset:9408
    v_exp_f32 v140, v140
    v_exp_f32 v141, v141
    v_exp_f32 v142, v142
    v_exp_f32 v143, v143
    v_cvt_pk_bf16_f32 v152, v128, v129
    v_cvt_pk_bf16_f32 v153, v130, v131
    v_cvt_pk_bf16_f32 v154, v132, v133
    v_cvt_pk_bf16_f32 v155, v134, v135
    v_cvt_pk_bf16_f32 v156, v136, v137
    v_cvt_pk_bf16_f32 v157, v138, v139
    v_cvt_pk_bf16_f32 v158, v140, v141
    v_cvt_pk_bf16_f32 v159, v142, v143
    v_add_u32 v34, 5376, v34
    v_add_u32 v35, 5376, v35
    v_add_u32 v36, 5376, v36
    v_add_u32 v37, 5376, v37
Lalast_1049:
    s_waitcnt lgkmcnt(7)
    v_mfma_f32_32x32x16_bf16 v[128:143], v[88:91], v[72:75], v[18:33]
    v_exp_f32 v112, v112
    v_exp_f32 v113, v113
    v_exp_f32 v114, v114
    v_exp_f32 v115, v115
    v_mfma_f32_32x32x16_bf16 v[128:143], v[92:95], v[76:79], v[128:143]
    v_exp_f32 v116, v116
    v_exp_f32 v117, v117
    v_exp_f32 v118, v118
    v_exp_f32 v119, v119
    v_mfma_f32_32x32x16_bf16 v[224:239], v[104:107], v[152:155], v[224:239]
    ds_read_b64_tr_b16 v[104:105], v37 offset:0
    ds_read_b64_tr_b16 v[106:107], v37 offset:1344
    v_exp_f32 v120, v120
    v_exp_f32 v121, v121
    v_exp_f32 v122, v122
    v_exp_f32 v123, v123
    v_mfma_f32_32x32x16_bf16 v[224:239], v[108:111], v[156:159], v[224:239]
    ds_read_b64_tr_b16 v[108:109], v37 offset:2688
    ds_read_b64_tr_b16 v[110:111], v37 offset:4032
    v_exp_f32 v124, v124
    v_exp_f32 v125, v125
    v_exp_f32 v126, v126
    v_exp_f32 v127, v127
    v_cvt_pk_bf16_f32 v144, v112, v113
    v_cvt_pk_bf16_f32 v145, v114, v115
    v_cvt_pk_bf16_f32 v146, v116, v117
    v_cvt_pk_bf16_f32 v147, v118, v119
    v_cvt_pk_bf16_f32 v148, v120, v121
    v_cvt_pk_bf16_f32 v149, v122, v123
    v_cvt_pk_bf16_f32 v150, v124, v125
    v_cvt_pk_bf16_f32 v151, v126, v127
    s_waitcnt lgkmcnt(4)
    v_exp_f32 v128, v128
    v_exp_f32 v129, v129
    v_exp_f32 v130, v130
    v_exp_f32 v131, v131
    v_exp_f32 v132, v132
    v_exp_f32 v133, v133
    v_exp_f32 v134, v134
    v_exp_f32 v135, v135
    v_mfma_f32_32x32x16_bf16 v[208:223], v[96:99], v[144:147], v[208:223]
    v_exp_f32 v136, v136
    v_exp_f32 v137, v137
    v_exp_f32 v138, v138
    v_exp_f32 v139, v139
    v_mfma_f32_32x32x16_bf16 v[208:223], v[100:103], v[148:151], v[208:223]
    v_exp_f32 v140, v140
    v_exp_f32 v141, v141
    v_exp_f32 v142, v142
    v_exp_f32 v143, v143
    v_cvt_pk_bf16_f32 v152, v128, v129
    v_cvt_pk_bf16_f32 v153, v130, v131
    v_cvt_pk_bf16_f32 v154, v132, v133
    v_cvt_pk_bf16_f32 v155, v134, v135
    v_cvt_pk_bf16_f32 v156, v136, v137
    v_cvt_pk_bf16_f32 v157, v138, v139
    v_cvt_pk_bf16_f32 v158, v140, v141
    v_cvt_pk_bf16_f32 v159, v142, v143
    s_waitcnt lgkmcnt(0)
    v_mfma_f32_32x32x16_bf16 v[224:239], v[104:107], v[152:155], v[224:239]
    v_mfma_f32_32x32x16_bf16 v[224:239], v[108:111], v[156:159], v[224:239]
Ladone_1050:
    v_mov_b32 v194, v216
    v_mov_b32 v192, v216
    v_nop
    s_nop 0
    v_permlane32_swap_b32 v194, v192
    s_nop 6
    v_mov_b32 v194, v232
    v_mov_b32 v193, v232
    v_nop
    s_nop 0
    v_permlane32_swap_b32 v194, v193
    v_mov_b32 v196, 0x2b800000
    v_mov_b32 v197, 0x53800000
    v_cmp_ge_f32 s[86:87], v192, v196
    v_cmp_le_f32 s[88:89], v192, v197
    s_nop 3
    s_and_b64 s[86:87], s[86:87], s[88:89]
    v_cmp_ge_f32 s[88:89], v193, v196
    s_nop 3
    s_and_b64 s[86:87], s[86:87], s[88:89]
    v_cmp_le_f32 s[88:89], v193, v197
    s_nop 3
    s_and_b64 s[86:87], s[86:87], s[88:89]
    s_cmp_eq_u64 s[86:87], exec
    s_cbranch_scc0 Lfallback_1052
Lnorm_1053:
    v_rcp_f32 v194, v192
    v_rcp_f32 v196, v193
    s_lshl_b32 s87, s69, 5
    v_and_b32 v198, 31, v0
    v_add_u32 v198, s87, v198
    v_mul_u32_u24 v198, 80, v198
    v_add_u32 v198, 147456, v198
    v_lshrrev_b32 v199, 5, v0
    v_lshl_add_u32 v199, v199, 3, v198
    v_pk_mul_f32 v[208:209], v[208:209], v[194:195] op_sel_hi:[1,0]
    v_pk_mul_f32 v[210:211], v[210:211], v[194:195] op_sel_hi:[1,0]
    v_cvt_pk_bf16_f32 v208, v208, v209
    v_cvt_pk_bf16_f32 v209, v210, v211
    ds_write_b64 v199, v[208:209] offset:0
    v_pk_mul_f32 v[212:213], v[212:213], v[194:195] op_sel_hi:[1,0]
    v_pk_mul_f32 v[214:215], v[214:215], v[194:195] op_sel_hi:[1,0]
    v_cvt_pk_bf16_f32 v212, v212, v213
    v_cvt_pk_bf16_f32 v213, v214, v215
    ds_write_b64 v199, v[212:213] offset:16
    v_pk_mul_f32 v[216:217], v[216:217], v[194:195] op_sel_hi:[1,0]
    v_pk_mul_f32 v[218:219], v[218:219], v[194:195] op_sel_hi:[1,0]
    v_cvt_pk_bf16_f32 v216, v216, v217
    v_cvt_pk_bf16_f32 v217, v218, v219
    s_mov_b32 exec_hi, 0
    ds_write_b64 v198, v[216:217] offset:32
    s_mov_b64 exec, -1
    v_pk_mul_f32 v[224:225], v[224:225], v[196:197] op_sel_hi:[1,0]
    v_pk_mul_f32 v[226:227], v[226:227], v[196:197] op_sel_hi:[1,0]
    v_cvt_pk_bf16_f32 v224, v224, v225
    v_cvt_pk_bf16_f32 v225, v226, v227
    ds_write_b64 v199, v[224:225] offset:40
    v_pk_mul_f32 v[228:229], v[228:229], v[196:197] op_sel_hi:[1,0]
    v_pk_mul_f32 v[230:231], v[230:231], v[196:197] op_sel_hi:[1,0]
    v_cvt_pk_bf16_f32 v228, v228, v229
    v_cvt_pk_bf16_f32 v229, v230, v231
    ds_write_b64 v199, v[228:229] offset:56
    v_pk_mul_f32 v[232:233], v[232:233], v[196:197] op_sel_hi:[1,0]
    v_pk_mul_f32 v[234:235], v[234:235], v[196:197] op_sel_hi:[1,0]
    v_cvt_pk_bf16_f32 v232, v232, v233
    v_cvt_pk_bf16_f32 v233, v234, v235
    s_mov_b32 exec_hi, 0
    ds_write_b64 v198, v[232:233] offset:72
    s_mov_b64 exec, -1
    s_waitcnt lgkmcnt(0)
    s_mov_b32 s80, 0
    v_add_u32 v199, s80, v38
    v_add_u32 v200, s80, v39
    v_add_u32 v201, s80, v40
    s_barrier
    s_lshl_b32 s86, s74, 6
    s_lshl_b32 s87, s95, 5
    s_add_u32 s86, s86, s87
    s_lshl_b32 s87, s94, 4
    s_add_u32 s86, s86, s87
    v_and_b32 v224, 15, v0
    v_add_u32 v224, s86, v224
    v_lshlrev_b32 v224, 1, v224
    buffer_load_ushort v53, v224, s[60:63], 0 offen
    ds_read_b64_tr_b16 v[156:157], v200 offset:0
    ds_read_b64_tr_b16 v[158:159], v200 offset:2048
    ds_read_b64_tr_b16 v[160:161], v201 offset:0
    ds_read_b64_tr_b16 v[162:163], v201 offset:2048
    ds_read_b64_tr_b16 v[136:137], v199 offset:0
    ds_read_b64_tr_b16 v[138:139], v199 offset:2560
    ds_read_b64_tr_b16 v[140:141], v199 offset:32
    ds_read_b64_tr_b16 v[142:143], v199 offset:2592
    ds_read_b64_tr_b16 v[144:145], v199 offset:64
    ds_read_b64_tr_b16 v[146:147], v199 offset:2624
    ds_read_b64_tr_b16 v[148:149], v199 offset:96
    ds_read_b64_tr_b16 v[150:151], v199 offset:2656
    ds_read_b64_tr_b16 v[152:153], v199 offset:128
    ds_read_b64_tr_b16 v[154:155], v199 offset:2688
    s_waitcnt lgkmcnt(0)
    v_mfma_f32_16x16x32_bf16 v[64:67], v[136:139], v[156:159], 0
    ds_read_b64_tr_b16 v[184:185], v200 offset:4096
    ds_read_b64_tr_b16 v[186:187], v200 offset:6144
    v_mfma_f32_16x16x32_bf16 v[68:71], v[136:139], v[160:163], 0
    ds_read_b64_tr_b16 v[188:189], v201 offset:4096
    v_mfma_f32_16x16x32_bf16 v[72:75], v[140:143], v[156:159], 0
    ds_read_b64_tr_b16 v[190:191], v201 offset:6144
    ds_read_b64_tr_b16 v[164:165], v199 offset:5120
    v_mfma_f32_16x16x32_bf16 v[76:79], v[140:143], v[160:163], 0
    ds_read_b64_tr_b16 v[166:167], v199 offset:7680
    v_mfma_f32_16x16x32_bf16 v[80:83], v[144:147], v[156:159], 0
    ds_read_b64_tr_b16 v[168:169], v199 offset:5152
    v_mfma_f32_16x16x32_bf16 v[84:87], v[144:147], v[160:163], 0
    ds_read_b64_tr_b16 v[170:171], v199 offset:7712
    ds_read_b64_tr_b16 v[172:173], v199 offset:5184
    v_mfma_f32_16x16x32_bf16 v[88:91], v[148:151], v[156:159], 0
    ds_read_b64_tr_b16 v[174:175], v199 offset:7744
    v_mfma_f32_16x16x32_bf16 v[92:95], v[148:151], v[160:163], 0
    ds_read_b64_tr_b16 v[176:177], v199 offset:5216
    ds_read_b64_tr_b16 v[178:179], v199 offset:7776
    v_mfma_f32_16x16x32_bf16 v[96:99], v[152:155], v[156:159], 0
    ds_read_b64_tr_b16 v[180:181], v199 offset:5248
    v_mfma_f32_16x16x32_bf16 v[100:103], v[152:155], v[160:163], 0
    ds_read_b64_tr_b16 v[182:183], v199 offset:7808
    s_add_u32 s80, s80, 36864
    s_cmp_eq_u32 s80, 147456
    s_cselect_b32 s80, 0, s80
    s_waitcnt lgkmcnt(0)
    v_add_u32 v199, s80, v38
    v_add_u32 v200, s80, v39
    v_add_u32 v201, s80, v40
    s_barrier
    v_mfma_f32_16x16x32_bf16 v[64:67], v[164:167], v[184:187], v[64:67]
    ds_read_b64_tr_b16 v[156:157], v200 offset:0
    ds_read_b64_tr_b16 v[158:159], v200 offset:2048
    v_mfma_f32_16x16x32_bf16 v[68:71], v[164:167], v[188:191], v[68:71]
    ds_read_b64_tr_b16 v[160:161], v201 offset:0
    v_mfma_f32_16x16x32_bf16 v[72:75], v[168:171], v[184:187], v[72:75]
    ds_read_b64_tr_b16 v[162:163], v201 offset:2048
    ds_read_b64_tr_b16 v[136:137], v199 offset:0
    v_mfma_f32_16x16x32_bf16 v[76:79], v[168:171], v[188:191], v[76:79]
    ds_read_b64_tr_b16 v[138:139], v199 offset:2560
    v_mfma_f32_16x16x32_bf16 v[80:83], v[172:175], v[184:187], v[80:83]
    ds_read_b64_tr_b16 v[140:141], v199 offset:32
    v_mfma_f32_16x16x32_bf16 v[84:87], v[172:175], v[188:191], v[84:87]
    ds_read_b64_tr_b16 v[142:143], v199 offset:2592
    ds_read_b64_tr_b16 v[144:145], v199 offset:64
    v_mfma_f32_16x16x32_bf16 v[88:91], v[176:179], v[184:187], v[88:91]
    ds_read_b64_tr_b16 v[146:147], v199 offset:2624
    v_mfma_f32_16x16x32_bf16 v[92:95], v[176:179], v[188:191], v[92:95]
    ds_read_b64_tr_b16 v[148:149], v199 offset:96
    ds_read_b64_tr_b16 v[150:151], v199 offset:2656
    v_mfma_f32_16x16x32_bf16 v[96:99], v[180:183], v[184:187], v[96:99]
    ds_read_b64_tr_b16 v[152:153], v199 offset:128
    v_mfma_f32_16x16x32_bf16 v[100:103], v[180:183], v[188:191], v[100:103]
    ds_read_b64_tr_b16 v[154:155], v199 offset:2688
    s_waitcnt lgkmcnt(0)
    v_mfma_f32_16x16x32_bf16 v[64:67], v[136:139], v[156:159], v[64:67]
    ds_read_b64_tr_b16 v[184:185], v200 offset:4096
    ds_read_b64_tr_b16 v[186:187], v200 offset:6144
    v_mfma_f32_16x16x32_bf16 v[68:71], v[136:139], v[160:163], v[68:71]
    ds_read_b64_tr_b16 v[188:189], v201 offset:4096
    v_mfma_f32_16x16x32_bf16 v[72:75], v[140:143], v[156:159], v[72:75]
    ds_read_b64_tr_b16 v[190:191], v201 offset:6144
    ds_read_b64_tr_b16 v[164:165], v199 offset:5120
    v_mfma_f32_16x16x32_bf16 v[76:79], v[140:143], v[160:163], v[76:79]
    ds_read_b64_tr_b16 v[166:167], v199 offset:7680
    v_mfma_f32_16x16x32_bf16 v[80:83], v[144:147], v[156:159], v[80:83]
    ds_read_b64_tr_b16 v[168:169], v199 offset:5152
    v_mfma_f32_16x16x32_bf16 v[84:87], v[144:147], v[160:163], v[84:87]
    ds_read_b64_tr_b16 v[170:171], v199 offset:7712
    ds_read_b64_tr_b16 v[172:173], v199 offset:5184
    v_mfma_f32_16x16x32_bf16 v[88:91], v[148:151], v[156:159], v[88:91]
    ds_read_b64_tr_b16 v[174:175], v199 offset:7744
    v_mfma_f32_16x16x32_bf16 v[92:95], v[148:151], v[160:163], v[92:95]
    ds_read_b64_tr_b16 v[176:177], v199 offset:5216
    ds_read_b64_tr_b16 v[178:179], v199 offset:7776
    v_mfma_f32_16x16x32_bf16 v[96:99], v[152:155], v[156:159], v[96:99]
    ds_read_b64_tr_b16 v[180:181], v199 offset:5248
    v_mfma_f32_16x16x32_bf16 v[100:103], v[152:155], v[160:163], v[100:103]
    ds_read_b64_tr_b16 v[182:183], v199 offset:7808
    s_add_u32 s80, s80, 36864
    s_cmp_eq_u32 s80, 147456
    s_cselect_b32 s80, 0, s80
    s_waitcnt lgkmcnt(0)
    v_add_u32 v199, s80, v38
    v_add_u32 v200, s80, v39
    v_add_u32 v201, s80, v40
    s_barrier
    v_mfma_f32_16x16x32_bf16 v[64:67], v[164:167], v[184:187], v[64:67]
    ds_read_b64_tr_b16 v[156:157], v200 offset:0
    ds_read_b64_tr_b16 v[158:159], v200 offset:2048
    v_mfma_f32_16x16x32_bf16 v[68:71], v[164:167], v[188:191], v[68:71]
    ds_read_b64_tr_b16 v[160:161], v201 offset:0
    v_mfma_f32_16x16x32_bf16 v[72:75], v[168:171], v[184:187], v[72:75]
    ds_read_b64_tr_b16 v[162:163], v201 offset:2048
    ds_read_b64_tr_b16 v[136:137], v199 offset:0
    v_mfma_f32_16x16x32_bf16 v[76:79], v[168:171], v[188:191], v[76:79]
    ds_read_b64_tr_b16 v[138:139], v199 offset:2560
    v_mfma_f32_16x16x32_bf16 v[80:83], v[172:175], v[184:187], v[80:83]
    ds_read_b64_tr_b16 v[140:141], v199 offset:32
    v_mfma_f32_16x16x32_bf16 v[84:87], v[172:175], v[188:191], v[84:87]
    ds_read_b64_tr_b16 v[142:143], v199 offset:2592
    ds_read_b64_tr_b16 v[144:145], v199 offset:64
    v_mfma_f32_16x16x32_bf16 v[88:91], v[176:179], v[184:187], v[88:91]
    ds_read_b64_tr_b16 v[146:147], v199 offset:2624
    v_mfma_f32_16x16x32_bf16 v[92:95], v[176:179], v[188:191], v[92:95]
    ds_read_b64_tr_b16 v[148:149], v199 offset:96
    ds_read_b64_tr_b16 v[150:151], v199 offset:2656
    v_mfma_f32_16x16x32_bf16 v[96:99], v[180:183], v[184:187], v[96:99]
    ds_read_b64_tr_b16 v[152:153], v199 offset:128
    v_mfma_f32_16x16x32_bf16 v[100:103], v[180:183], v[188:191], v[100:103]
    ds_read_b64_tr_b16 v[154:155], v199 offset:2688
    s_waitcnt lgkmcnt(0)
    v_mfma_f32_16x16x32_bf16 v[64:67], v[136:139], v[156:159], v[64:67]
    ds_read_b64_tr_b16 v[184:185], v200 offset:4096
    ds_read_b64_tr_b16 v[186:187], v200 offset:6144
    v_mfma_f32_16x16x32_bf16 v[68:71], v[136:139], v[160:163], v[68:71]
    ds_read_b64_tr_b16 v[188:189], v201 offset:4096
    v_mfma_f32_16x16x32_bf16 v[72:75], v[140:143], v[156:159], v[72:75]
    ds_read_b64_tr_b16 v[190:191], v201 offset:6144
    ds_read_b64_tr_b16 v[164:165], v199 offset:5120
    v_mfma_f32_16x16x32_bf16 v[76:79], v[140:143], v[160:163], v[76:79]
    ds_read_b64_tr_b16 v[166:167], v199 offset:7680
    v_mfma_f32_16x16x32_bf16 v[80:83], v[144:147], v[156:159], v[80:83]
    ds_read_b64_tr_b16 v[168:169], v199 offset:5152
    v_mfma_f32_16x16x32_bf16 v[84:87], v[144:147], v[160:163], v[84:87]
    ds_read_b64_tr_b16 v[170:171], v199 offset:7712
    ds_read_b64_tr_b16 v[172:173], v199 offset:5184
    v_mfma_f32_16x16x32_bf16 v[88:91], v[148:151], v[156:159], v[88:91]
    ds_read_b64_tr_b16 v[174:175], v199 offset:7744
    v_mfma_f32_16x16x32_bf16 v[92:95], v[148:151], v[160:163], v[92:95]
    ds_read_b64_tr_b16 v[176:177], v199 offset:5216
    ds_read_b64_tr_b16 v[178:179], v199 offset:7776
    v_mfma_f32_16x16x32_bf16 v[96:99], v[152:155], v[156:159], v[96:99]
    ds_read_b64_tr_b16 v[180:181], v199 offset:5248
    v_mfma_f32_16x16x32_bf16 v[100:103], v[152:155], v[160:163], v[100:103]
    ds_read_b64_tr_b16 v[182:183], v199 offset:7808
    s_add_u32 s80, s80, 36864
    s_cmp_eq_u32 s80, 147456
    s_cselect_b32 s80, 0, s80
    s_waitcnt lgkmcnt(0)
    v_add_u32 v199, s80, v38
    v_add_u32 v200, s80, v39
    v_add_u32 v201, s80, v40
    s_barrier
    v_mfma_f32_16x16x32_bf16 v[64:67], v[164:167], v[184:187], v[64:67]
    ds_read_b64_tr_b16 v[156:157], v200 offset:0
    ds_read_b64_tr_b16 v[158:159], v200 offset:2048
    v_mfma_f32_16x16x32_bf16 v[68:71], v[164:167], v[188:191], v[68:71]
    ds_read_b64_tr_b16 v[160:161], v201 offset:0
    v_mfma_f32_16x16x32_bf16 v[72:75], v[168:171], v[184:187], v[72:75]
    ds_read_b64_tr_b16 v[162:163], v201 offset:2048
    ds_read_b64_tr_b16 v[136:137], v199 offset:0
    v_mfma_f32_16x16x32_bf16 v[76:79], v[168:171], v[188:191], v[76:79]
    ds_read_b64_tr_b16 v[138:139], v199 offset:2560
    v_mfma_f32_16x16x32_bf16 v[80:83], v[172:175], v[184:187], v[80:83]
    ds_read_b64_tr_b16 v[140:141], v199 offset:32
    v_mfma_f32_16x16x32_bf16 v[84:87], v[172:175], v[188:191], v[84:87]
    ds_read_b64_tr_b16 v[142:143], v199 offset:2592
    ds_read_b64_tr_b16 v[144:145], v199 offset:64
    v_mfma_f32_16x16x32_bf16 v[88:91], v[176:179], v[184:187], v[88:91]
    ds_read_b64_tr_b16 v[146:147], v199 offset:2624
    v_mfma_f32_16x16x32_bf16 v[92:95], v[176:179], v[188:191], v[92:95]
    ds_read_b64_tr_b16 v[148:149], v199 offset:96
    ds_read_b64_tr_b16 v[150:151], v199 offset:2656
    v_mfma_f32_16x16x32_bf16 v[96:99], v[180:183], v[184:187], v[96:99]
    ds_read_b64_tr_b16 v[152:153], v199 offset:128
    v_mfma_f32_16x16x32_bf16 v[100:103], v[180:183], v[188:191], v[100:103]
    ds_read_b64_tr_b16 v[154:155], v199 offset:2688
    s_waitcnt lgkmcnt(0)
    v_mfma_f32_16x16x32_bf16 v[64:67], v[136:139], v[156:159], v[64:67]
    ds_read_b64_tr_b16 v[184:185], v200 offset:4096
    ds_read_b64_tr_b16 v[186:187], v200 offset:6144
    v_mfma_f32_16x16x32_bf16 v[68:71], v[136:139], v[160:163], v[68:71]
    ds_read_b64_tr_b16 v[188:189], v201 offset:4096
    v_mfma_f32_16x16x32_bf16 v[72:75], v[140:143], v[156:159], v[72:75]
    ds_read_b64_tr_b16 v[190:191], v201 offset:6144
    ds_read_b64_tr_b16 v[164:165], v199 offset:5120
    v_mfma_f32_16x16x32_bf16 v[76:79], v[140:143], v[160:163], v[76:79]
    ds_read_b64_tr_b16 v[166:167], v199 offset:7680
    v_mfma_f32_16x16x32_bf16 v[80:83], v[144:147], v[156:159], v[80:83]
    ds_read_b64_tr_b16 v[168:169], v199 offset:5152
    v_mfma_f32_16x16x32_bf16 v[84:87], v[144:147], v[160:163], v[84:87]
    ds_read_b64_tr_b16 v[170:171], v199 offset:7712
    ds_read_b64_tr_b16 v[172:173], v199 offset:5184
    v_mfma_f32_16x16x32_bf16 v[88:91], v[148:151], v[156:159], v[88:91]
    ds_read_b64_tr_b16 v[174:175], v199 offset:7744
    v_mfma_f32_16x16x32_bf16 v[92:95], v[148:151], v[160:163], v[92:95]
    ds_read_b64_tr_b16 v[176:177], v199 offset:5216
    ds_read_b64_tr_b16 v[178:179], v199 offset:7776
    v_mfma_f32_16x16x32_bf16 v[96:99], v[152:155], v[156:159], v[96:99]
    ds_read_b64_tr_b16 v[180:181], v199 offset:5248
    v_mfma_f32_16x16x32_bf16 v[100:103], v[152:155], v[160:163], v[100:103]
    ds_read_b64_tr_b16 v[182:183], v199 offset:7808
    s_add_u32 s80, s80, 36864
    s_cmp_eq_u32 s80, 147456
    s_cselect_b32 s80, 0, s80
    s_waitcnt lgkmcnt(0)
    v_add_u32 v199, s80, v38
    v_add_u32 v200, s80, v39
    v_add_u32 v201, s80, v40
    s_mov_b32 s81, 7
Lloop_1054:
    s_barrier
    v_mfma_f32_16x16x32_bf16 v[64:67], v[164:167], v[184:187], v[64:67]
    ds_read_b64_tr_b16 v[156:157], v200 offset:0
    ds_read_b64_tr_b16 v[158:159], v200 offset:2048
    v_mfma_f32_16x16x32_bf16 v[68:71], v[164:167], v[188:191], v[68:71]
    ds_read_b64_tr_b16 v[160:161], v201 offset:0
    v_mfma_f32_16x16x32_bf16 v[72:75], v[168:171], v[184:187], v[72:75]
    ds_read_b64_tr_b16 v[162:163], v201 offset:2048
    ds_read_b64_tr_b16 v[136:137], v199 offset:0
    v_mfma_f32_16x16x32_bf16 v[76:79], v[168:171], v[188:191], v[76:79]
    ds_read_b64_tr_b16 v[138:139], v199 offset:2560
    v_mfma_f32_16x16x32_bf16 v[80:83], v[172:175], v[184:187], v[80:83]
    ds_read_b64_tr_b16 v[140:141], v199 offset:32
    v_mfma_f32_16x16x32_bf16 v[84:87], v[172:175], v[188:191], v[84:87]
    ds_read_b64_tr_b16 v[142:143], v199 offset:2592
    ds_read_b64_tr_b16 v[144:145], v199 offset:64
    v_mfma_f32_16x16x32_bf16 v[88:91], v[176:179], v[184:187], v[88:91]
    ds_read_b64_tr_b16 v[146:147], v199 offset:2624
    v_mfma_f32_16x16x32_bf16 v[92:95], v[176:179], v[188:191], v[92:95]
    ds_read_b64_tr_b16 v[148:149], v199 offset:96
    ds_read_b64_tr_b16 v[150:151], v199 offset:2656
    v_mfma_f32_16x16x32_bf16 v[96:99], v[180:183], v[184:187], v[96:99]
    ds_read_b64_tr_b16 v[152:153], v199 offset:128
    v_mfma_f32_16x16x32_bf16 v[100:103], v[180:183], v[188:191], v[100:103]
    ds_read_b64_tr_b16 v[154:155], v199 offset:2688
    s_waitcnt lgkmcnt(0)
    v_mfma_f32_16x16x32_bf16 v[64:67], v[136:139], v[156:159], v[64:67]
    ds_read_b64_tr_b16 v[184:185], v200 offset:4096
    ds_read_b64_tr_b16 v[186:187], v200 offset:6144
    v_mfma_f32_16x16x32_bf16 v[68:71], v[136:139], v[160:163], v[68:71]
    ds_read_b64_tr_b16 v[188:189], v201 offset:4096
    v_mfma_f32_16x16x32_bf16 v[72:75], v[140:143], v[156:159], v[72:75]
    ds_read_b64_tr_b16 v[190:191], v201 offset:6144
    ds_read_b64_tr_b16 v[164:165], v199 offset:5120
    v_mfma_f32_16x16x32_bf16 v[76:79], v[140:143], v[160:163], v[76:79]
    ds_read_b64_tr_b16 v[166:167], v199 offset:7680
    v_mfma_f32_16x16x32_bf16 v[80:83], v[144:147], v[156:159], v[80:83]
    ds_read_b64_tr_b16 v[168:169], v199 offset:5152
    v_mfma_f32_16x16x32_bf16 v[84:87], v[144:147], v[160:163], v[84:87]
    ds_read_b64_tr_b16 v[170:171], v199 offset:7712
    ds_read_b64_tr_b16 v[172:173], v199 offset:5184
    v_mfma_f32_16x16x32_bf16 v[88:91], v[148:151], v[156:159], v[88:91]
    ds_read_b64_tr_b16 v[174:175], v199 offset:7744
    v_mfma_f32_16x16x32_bf16 v[92:95], v[148:151], v[160:163], v[92:95]
    ds_read_b64_tr_b16 v[176:177], v199 offset:5216
    ds_read_b64_tr_b16 v[178:179], v199 offset:7776
    v_mfma_f32_16x16x32_bf16 v[96:99], v[152:155], v[156:159], v[96:99]
    ds_read_b64_tr_b16 v[180:181], v199 offset:5248
    v_mfma_f32_16x16x32_bf16 v[100:103], v[152:155], v[160:163], v[100:103]
    ds_read_b64_tr_b16 v[182:183], v199 offset:7808
    s_add_u32 s80, s80, 36864
    s_cmp_eq_u32 s80, 147456
    s_cselect_b32 s80, 0, s80
    s_waitcnt lgkmcnt(0)
    v_add_u32 v199, s80, v38
    v_add_u32 v200, s80, v39
    v_add_u32 v201, s80, v40
    s_sub_u32 s81, s81, 1
    s_cmp_lg_u32 s81, 0
    s_cbranch_scc1 Lloop_1054
    s_barrier
    v_mfma_f32_16x16x32_bf16 v[64:67], v[164:167], v[184:187], v[64:67]
    ds_read_b64_tr_b16 v[156:157], v200 offset:0
    ds_read_b64_tr_b16 v[158:159], v200 offset:2048
    v_mfma_f32_16x16x32_bf16 v[68:71], v[164:167], v[188:191], v[68:71]
    ds_read_b64_tr_b16 v[160:161], v201 offset:0
    v_mfma_f32_16x16x32_bf16 v[72:75], v[168:171], v[184:187], v[72:75]
    ds_read_b64_tr_b16 v[162:163], v201 offset:2048
    ds_read_b64_tr_b16 v[136:137], v199 offset:0
    v_mfma_f32_16x16x32_bf16 v[76:79], v[168:171], v[188:191], v[76:79]
    ds_read_b64_tr_b16 v[138:139], v199 offset:2560
    v_mfma_f32_16x16x32_bf16 v[80:83], v[172:175], v[184:187], v[80:83]
    ds_read_b64_tr_b16 v[140:141], v199 offset:32
    v_mfma_f32_16x16x32_bf16 v[84:87], v[172:175], v[188:191], v[84:87]
    ds_read_b64_tr_b16 v[142:143], v199 offset:2592
    ds_read_b64_tr_b16 v[144:145], v199 offset:64
    v_mfma_f32_16x16x32_bf16 v[88:91], v[176:179], v[184:187], v[88:91]
    ds_read_b64_tr_b16 v[146:147], v199 offset:2624
    v_mfma_f32_16x16x32_bf16 v[92:95], v[176:179], v[188:191], v[92:95]
    ds_read_b64_tr_b16 v[148:149], v199 offset:96
    ds_read_b64_tr_b16 v[150:151], v199 offset:2656
    v_mfma_f32_16x16x32_bf16 v[96:99], v[180:183], v[184:187], v[96:99]
    ds_read_b64_tr_b16 v[152:153], v199 offset:128
    v_mfma_f32_16x16x32_bf16 v[100:103], v[180:183], v[188:191], v[100:103]
    ds_read_b64_tr_b16 v[154:155], v199 offset:2688
    s_waitcnt lgkmcnt(0)
    v_mfma_f32_16x16x32_bf16 v[64:67], v[136:139], v[156:159], v[64:67]
    ds_read_b64_tr_b16 v[184:185], v200 offset:4096
    ds_read_b64_tr_b16 v[186:187], v200 offset:6144
    v_mfma_f32_16x16x32_bf16 v[68:71], v[136:139], v[160:163], v[68:71]
    ds_read_b64_tr_b16 v[188:189], v201 offset:4096
    v_mfma_f32_16x16x32_bf16 v[72:75], v[140:143], v[156:159], v[72:75]
    ds_read_b64_tr_b16 v[190:191], v201 offset:6144
    ds_read_b64_tr_b16 v[164:165], v199 offset:5120
    v_mfma_f32_16x16x32_bf16 v[76:79], v[140:143], v[160:163], v[76:79]
    ds_read_b64_tr_b16 v[166:167], v199 offset:7680
    v_mfma_f32_16x16x32_bf16 v[80:83], v[144:147], v[156:159], v[80:83]
    ds_read_b64_tr_b16 v[168:169], v199 offset:5152
    v_mfma_f32_16x16x32_bf16 v[84:87], v[144:147], v[160:163], v[84:87]
    ds_read_b64_tr_b16 v[170:171], v199 offset:7712
    ds_read_b64_tr_b16 v[172:173], v199 offset:5184
    v_mfma_f32_16x16x32_bf16 v[88:91], v[148:151], v[156:159], v[88:91]
    ds_read_b64_tr_b16 v[174:175], v199 offset:7744
    v_mfma_f32_16x16x32_bf16 v[92:95], v[148:151], v[160:163], v[92:95]
    ds_read_b64_tr_b16 v[176:177], v199 offset:5216
    ds_read_b64_tr_b16 v[178:179], v199 offset:7776
    v_mfma_f32_16x16x32_bf16 v[96:99], v[152:155], v[156:159], v[96:99]
    ds_read_b64_tr_b16 v[180:181], v199 offset:5248
    v_mfma_f32_16x16x32_bf16 v[100:103], v[152:155], v[160:163], v[100:103]
    ds_read_b64_tr_b16 v[182:183], v199 offset:7808
    s_add_u32 s80, s80, 36864
    s_cmp_eq_u32 s80, 147456
    s_cselect_b32 s80, 0, s80
    s_waitcnt lgkmcnt(0)
    v_add_u32 v199, s80, v38
    v_add_u32 v202, s80, v41
    v_add_u32 v203, s80, v42
    v_add_u32 v204, s80, v43
    v_add_u32 v205, s80, v44
    s_mov_b32 s81, 2
Lloop_1055:
    s_barrier
    v_mfma_f32_16x16x32_bf16 v[64:67], v[164:167], v[184:187], v[64:67]
    ds_read_b64 v[156:157], v202 offset:0
    ds_read_b64 v[158:159], v203 offset:0
    v_mfma_f32_16x16x32_bf16 v[68:71], v[164:167], v[188:191], v[68:71]
    ds_read_b64 v[160:161], v202 offset:4096
    v_mfma_f32_16x16x32_bf16 v[72:75], v[168:171], v[184:187], v[72:75]
    ds_read_b64 v[162:163], v203 offset:4096
    ds_read_b64_tr_b16 v[136:137], v199 offset:0
    v_mfma_f32_16x16x32_bf16 v[76:79], v[168:171], v[188:191], v[76:79]
    ds_read_b64_tr_b16 v[138:139], v199 offset:2560
    v_mfma_f32_16x16x32_bf16 v[80:83], v[172:175], v[184:187], v[80:83]
    ds_read_b64_tr_b16 v[140:141], v199 offset:32
    v_mfma_f32_16x16x32_bf16 v[84:87], v[172:175], v[188:191], v[84:87]
    ds_read_b64_tr_b16 v[142:143], v199 offset:2592
    ds_read_b64_tr_b16 v[144:145], v199 offset:64
    v_mfma_f32_16x16x32_bf16 v[88:91], v[176:179], v[184:187], v[88:91]
    ds_read_b64_tr_b16 v[146:147], v199 offset:2624
    v_mfma_f32_16x16x32_bf16 v[92:95], v[176:179], v[188:191], v[92:95]
    ds_read_b64_tr_b16 v[148:149], v199 offset:96
    ds_read_b64_tr_b16 v[150:151], v199 offset:2656
    v_mfma_f32_16x16x32_bf16 v[96:99], v[180:183], v[184:187], v[96:99]
    ds_read_b64_tr_b16 v[152:153], v199 offset:128
    v_mfma_f32_16x16x32_bf16 v[100:103], v[180:183], v[188:191], v[100:103]
    ds_read_b64_tr_b16 v[154:155], v199 offset:2688
    s_waitcnt lgkmcnt(0)
    v_mfma_f32_16x16x32_bf16 v[64:67], v[136:139], v[156:159], v[64:67]
    ds_read_b64 v[184:185], v204 offset:0
    ds_read_b64 v[186:187], v205 offset:0
    v_mfma_f32_16x16x32_bf16 v[68:71], v[136:139], v[160:163], v[68:71]
    ds_read_b64 v[188:189], v204 offset:4096
    v_mfma_f32_16x16x32_bf16 v[72:75], v[140:143], v[156:159], v[72:75]
    ds_read_b64 v[190:191], v205 offset:4096
    ds_read_b64_tr_b16 v[164:165], v199 offset:5120
    v_mfma_f32_16x16x32_bf16 v[76:79], v[140:143], v[160:163], v[76:79]
    ds_read_b64_tr_b16 v[166:167], v199 offset:7680
    v_mfma_f32_16x16x32_bf16 v[80:83], v[144:147], v[156:159], v[80:83]
    ds_read_b64_tr_b16 v[168:169], v199 offset:5152
    v_mfma_f32_16x16x32_bf16 v[84:87], v[144:147], v[160:163], v[84:87]
    ds_read_b64_tr_b16 v[170:171], v199 offset:7712
    ds_read_b64_tr_b16 v[172:173], v199 offset:5184
    v_mfma_f32_16x16x32_bf16 v[88:91], v[148:151], v[156:159], v[88:91]
    ds_read_b64_tr_b16 v[174:175], v199 offset:7744
    v_mfma_f32_16x16x32_bf16 v[92:95], v[148:151], v[160:163], v[92:95]
    ds_read_b64_tr_b16 v[176:177], v199 offset:5216
    ds_read_b64_tr_b16 v[178:179], v199 offset:7776
    v_mfma_f32_16x16x32_bf16 v[96:99], v[152:155], v[156:159], v[96:99]
    ds_read_b64_tr_b16 v[180:181], v199 offset:5248
    v_mfma_f32_16x16x32_bf16 v[100:103], v[152:155], v[160:163], v[100:103]
    ds_read_b64_tr_b16 v[182:183], v199 offset:7808
    s_add_u32 s80, s80, 36864
    s_cmp_eq_u32 s80, 147456
    s_cselect_b32 s80, 0, s80
    s_waitcnt lgkmcnt(0)
    v_add_u32 v199, s80, v38
    v_add_u32 v202, s80, v41
    v_add_u32 v203, s80, v42
    v_add_u32 v204, s80, v43
    v_add_u32 v205, s80, v44
    s_sub_u32 s81, s81, 1
    s_cmp_lg_u32 s81, 0
    s_cbranch_scc1 Lloop_1055
    s_lshl_b32 s87, s95, 5
    s_lshl_b32 s88, s94, 4
    s_add_u32 s87, s87, s88
    v_and_b32 v56, 15, v0
    v_add_u32 v56, s87, v56
    v_mul_u32_u24 v57, 160, v56
    v_lshrrev_b32 v1, 4, v0
    v_lshl_add_u32 v57, v1, 3, v57
    v_add_u32 v57, 147456, v57
    ds_read_b64 v[228:229], v57 offset:0
    ds_read_b64 v[230:231], v57 offset:32
    ds_read_b64 v[232:233], v57 offset:64
    ds_read_b64 v[234:235], v57 offset:96
    ds_read_b64 v[236:237], v57 offset:128
    s_lshl_b32 s86, s74, 6
    v_add_u32 v56, s86, v56
    v_mul_u32_u24 v56, 1280, v56
    s_mul_i32 s86, s75, 160
    v_add_u32 v56, s86, v56
    v_lshl_add_u32 v56, v1, 3, v56
    v_lshlrev_b32 v57, 4, v0
    s_xor_b32 s86, s69, 2
    s_mul_i32 s86, s86, 5120
    s_add_u32 s86, s86, 36864
    v_add_u32 v57, s86, v57
    s_mov_b32 s89, 0xffff0000
    s_waitcnt vmcnt(0) lgkmcnt(0)
    v_lshlrev_b32 v238, 16, v53
    v_lshlrev_b32 v208, 16, v228
    v_and_b32 v209, s89, v228
    v_lshlrev_b32 v210, 16, v229
    v_and_b32 v211, s89, v229
    v_lshlrev_b32 v212, 16, v230
    v_and_b32 v213, s89, v230
    v_lshlrev_b32 v214, 16, v231
    v_and_b32 v215, s89, v231
    v_lshlrev_b32 v216, 16, v232
    v_and_b32 v217, s89, v232
    v_lshlrev_b32 v218, 16, v233
    v_and_b32 v219, s89, v233
    v_lshlrev_b32 v220, 16, v234
    v_and_b32 v221, s89, v234
    v_lshlrev_b32 v222, 16, v235
    v_and_b32 v223, s89, v235
    v_lshlrev_b32 v224, 16, v236
    v_and_b32 v225, s89, v236
    v_lshlrev_b32 v226, 16, v237
    v_and_b32 v227, s89, v237
    v_pk_add_f32 v[208:209], v[208:209], v[238:239] op_sel_hi:[1,0]
    v_pk_add_f32 v[210:211], v[210:211], v[238:239] op_sel_hi:[1,0]
    v_pk_add_f32 v[212:213], v[212:213], v[238:239] op_sel_hi:[1,0]
    v_pk_add_f32 v[214:215], v[214:215], v[238:239] op_sel_hi:[1,0]
    v_pk_add_f32 v[216:217], v[216:217], v[238:239] op_sel_hi:[1,0]
    v_pk_add_f32 v[218:219], v[218:219], v[238:239] op_sel_hi:[1,0]
    v_pk_add_f32 v[220:221], v[220:221], v[238:239] op_sel_hi:[1,0]
    v_pk_add_f32 v[222:223], v[222:223], v[238:239] op_sel_hi:[1,0]
    v_pk_add_f32 v[224:225], v[224:225], v[238:239] op_sel_hi:[1,0]
    v_pk_add_f32 v[226:227], v[226:227], v[238:239] op_sel_hi:[1,0]
    s_mov_b32 s81, 3
Lloop_1056:
    s_barrier
    v_mfma_f32_16x16x32_bf16 v[64:67], v[164:167], v[184:187], v[64:67]
    ds_read_b64 v[156:157], v202 offset:0
    ds_read_b64 v[158:159], v203 offset:0
    v_mfma_f32_16x16x32_bf16 v[68:71], v[164:167], v[188:191], v[68:71]
    ds_read_b64 v[160:161], v202 offset:4096
    v_mfma_f32_16x16x32_bf16 v[72:75], v[168:171], v[184:187], v[72:75]
    ds_read_b64 v[162:163], v203 offset:4096
    ds_read_b64_tr_b16 v[136:137], v199 offset:0
    v_mfma_f32_16x16x32_bf16 v[76:79], v[168:171], v[188:191], v[76:79]
    ds_read_b64_tr_b16 v[138:139], v199 offset:2560
    v_mfma_f32_16x16x32_bf16 v[80:83], v[172:175], v[184:187], v[80:83]
    ds_read_b64_tr_b16 v[140:141], v199 offset:32
    v_mfma_f32_16x16x32_bf16 v[84:87], v[172:175], v[188:191], v[84:87]
    ds_read_b64_tr_b16 v[142:143], v199 offset:2592
    ds_read_b64_tr_b16 v[144:145], v199 offset:64
    v_mfma_f32_16x16x32_bf16 v[88:91], v[176:179], v[184:187], v[88:91]
    ds_read_b64_tr_b16 v[146:147], v199 offset:2624
    v_mfma_f32_16x16x32_bf16 v[92:95], v[176:179], v[188:191], v[92:95]
    ds_read_b64_tr_b16 v[148:149], v199 offset:96
    ds_read_b64_tr_b16 v[150:151], v199 offset:2656
    v_mfma_f32_16x16x32_bf16 v[96:99], v[180:183], v[184:187], v[96:99]
    ds_read_b64_tr_b16 v[152:153], v199 offset:128
    v_mfma_f32_16x16x32_bf16 v[100:103], v[180:183], v[188:191], v[100:103]
    ds_read_b64_tr_b16 v[154:155], v199 offset:2688
    s_waitcnt lgkmcnt(0)
    v_mfma_f32_16x16x32_bf16 v[64:67], v[136:139], v[156:159], v[64:67]
    ds_read_b64 v[184:185], v204 offset:0
    ds_read_b64 v[186:187], v205 offset:0
    v_mfma_f32_16x16x32_bf16 v[68:71], v[136:139], v[160:163], v[68:71]
    ds_read_b64 v[188:189], v204 offset:4096
    v_mfma_f32_16x16x32_bf16 v[72:75], v[140:143], v[156:159], v[72:75]
    ds_read_b64 v[190:191], v205 offset:4096
    ds_read_b64_tr_b16 v[164:165], v199 offset:5120
    v_mfma_f32_16x16x32_bf16 v[76:79], v[140:143], v[160:163], v[76:79]
    ds_read_b64_tr_b16 v[166:167], v199 offset:7680
    v_mfma_f32_16x16x32_bf16 v[80:83], v[144:147], v[156:159], v[80:83]
    ds_read_b64_tr_b16 v[168:169], v199 offset:5152
    v_mfma_f32_16x16x32_bf16 v[84:87], v[144:147], v[160:163], v[84:87]
    ds_read_b64_tr_b16 v[170:171], v199 offset:7712
    ds_read_b64_tr_b16 v[172:173], v199 offset:5184
    v_mfma_f32_16x16x32_bf16 v[88:91], v[148:151], v[156:159], v[88:91]
    ds_read_b64_tr_b16 v[174:175], v199 offset:7744
    v_mfma_f32_16x16x32_bf16 v[92:95], v[148:151], v[160:163], v[92:95]
    ds_read_b64_tr_b16 v[176:177], v199 offset:5216
    ds_read_b64_tr_b16 v[178:179], v199 offset:7776
    v_mfma_f32_16x16x32_bf16 v[96:99], v[152:155], v[156:159], v[96:99]
    ds_read_b64_tr_b16 v[180:181], v199 offset:5248
    v_mfma_f32_16x16x32_bf16 v[100:103], v[152:155], v[160:163], v[100:103]
    ds_read_b64_tr_b16 v[182:183], v199 offset:7808
    s_add_u32 s80, s80, 36864
    s_cmp_eq_u32 s80, 147456
    s_cselect_b32 s80, 0, s80
    s_waitcnt lgkmcnt(0)
    v_add_u32 v199, s80, v38
    v_add_u32 v202, s80, v41
    v_add_u32 v203, s80, v42
    v_add_u32 v204, s80, v43
    v_add_u32 v205, s80, v44
    s_sub_u32 s81, s81, 1
    s_cmp_lg_u32 s81, 0
    s_cbranch_scc1 Lloop_1056
    v_mfma_f32_16x16x32_bf16 v[64:67], v[164:167], v[184:187], v[64:67]
    v_mfma_f32_16x16x32_bf16 v[68:71], v[164:167], v[188:191], v[68:71]
    v_mfma_f32_16x16x32_bf16 v[72:75], v[168:171], v[184:187], v[72:75]
    v_mfma_f32_16x16x32_bf16 v[76:79], v[168:171], v[188:191], v[76:79]
    v_mfma_f32_16x16x32_bf16 v[80:83], v[172:175], v[184:187], v[80:83]
    v_mfma_f32_16x16x32_bf16 v[84:87], v[172:175], v[188:191], v[84:87]
    v_mfma_f32_16x16x32_bf16 v[88:91], v[176:179], v[184:187], v[88:91]
    v_mfma_f32_16x16x32_bf16 v[92:95], v[176:179], v[188:191], v[92:95]
    v_mfma_f32_16x16x32_bf16 v[96:99], v[180:183], v[184:187], v[96:99]
    v_mfma_f32_16x16x32_bf16 v[100:103], v[180:183], v[188:191], v[100:103]
    s_cmp_lg_u32 s94, 0
    s_cbranch_scc1 Lsel_1057
    v_lshlrev_b32 v206, 4, v0
    s_mul_i32 s86, s69, 5120
    s_add_u32 s86, s86, 36864
    v_add_u32 v206, s86, v206
    ds_write_b128 v206, v[68:71] offset:0
    ds_write_b128 v206, v[76:79] offset:1024
    ds_write_b128 v206, v[84:87] offset:2048
    ds_write_b128 v206, v[92:95] offset:3072
    ds_write_b128 v206, v[100:103] offset:4096
    s_waitcnt lgkmcnt(0)
    s_nop 7
    s_branch Lsele_1058
Lsel_1057:
    v_lshlrev_b32 v206, 4, v0
    s_mul_i32 s86, s69, 5120
    s_add_u32 s86, s86, 36864
    v_add_u32 v206, s86, v206
    ds_write_b128 v206, v[64:67] offset:0
    ds_write_b128 v206, v[72:75] offset:1024
    ds_write_b128 v206, v[80:83] offset:2048
    ds_write_b128 v206, v[88:91] offset:3072
    ds_write_b128 v206, v[96:99] offset:4096
    s_waitcnt lgkmcnt(0)
    s_nop 7
Lsele_1058:
    s_barrier
    s_cmp_lg_u32 s94, 0
    s_cbranch_scc1 Lsel_1059
    ds_read_b128 v[136:139], v57 offset:0
    ds_read_b128 v[140:143], v57 offset:1024
    ds_read_b128 v[144:147], v57 offset:2048
    ds_read_b128 v[148:151], v57 offset:3072
    ds_read_b128 v[152:155], v57 offset:4096
    v_pk_add_f32 v[64:65], v[64:65], v[208:209]
    v_pk_add_f32 v[66:67], v[66:67], v[210:211]
    v_pk_add_f32 v[72:73], v[72:73], v[212:213]
    v_pk_add_f32 v[74:75], v[74:75], v[214:215]
    v_pk_add_f32 v[80:81], v[80:81], v[216:217]
    v_pk_add_f32 v[82:83], v[82:83], v[218:219]
    v_pk_add_f32 v[88:89], v[88:89], v[220:221]
    v_pk_add_f32 v[90:91], v[90:91], v[222:223]
    v_pk_add_f32 v[96:97], v[96:97], v[224:225]
    v_pk_add_f32 v[98:99], v[98:99], v[226:227]
    s_waitcnt lgkmcnt(4)
    v_pk_add_f32 v[64:65], v[64:65], v[136:137]
    v_pk_add_f32 v[66:67], v[66:67], v[138:139]
    v_cvt_pk_bf16_f32 v64, v64, v65
    v_cvt_pk_bf16_f32 v65, v66, v67
    buffer_store_dwordx2 v[64:65], v56, s[52:55], 0 offen offset:0
    s_waitcnt lgkmcnt(3)
    v_pk_add_f32 v[72:73], v[72:73], v[140:141]
    v_pk_add_f32 v[74:75], v[74:75], v[142:143]
    v_cvt_pk_bf16_f32 v72, v72, v73
    v_cvt_pk_bf16_f32 v73, v74, v75
    buffer_store_dwordx2 v[72:73], v56, s[52:55], 0 offen offset:32
    s_waitcnt lgkmcnt(2)
    v_pk_add_f32 v[80:81], v[80:81], v[144:145]
    v_pk_add_f32 v[82:83], v[82:83], v[146:147]
    v_cvt_pk_bf16_f32 v80, v80, v81
    v_cvt_pk_bf16_f32 v81, v82, v83
    buffer_store_dwordx2 v[80:81], v56, s[52:55], 0 offen offset:64
    s_waitcnt lgkmcnt(1)
    v_pk_add_f32 v[88:89], v[88:89], v[148:149]
    v_pk_add_f32 v[90:91], v[90:91], v[150:151]
    v_cvt_pk_bf16_f32 v88, v88, v89
    v_cvt_pk_bf16_f32 v89, v90, v91
    buffer_store_dwordx2 v[88:89], v56, s[52:55], 0 offen offset:96
    s_waitcnt lgkmcnt(0)
    v_pk_add_f32 v[96:97], v[96:97], v[152:153]
    v_pk_add_f32 v[98:99], v[98:99], v[154:155]
    v_cvt_pk_bf16_f32 v96, v96, v97
    v_cvt_pk_bf16_f32 v97, v98, v99
    buffer_store_dwordx2 v[96:97], v56, s[52:55], 0 offen offset:128
    s_nop 7
    s_branch Lsele_1060
Lsel_1059:
    ds_read_b128 v[136:139], v57 offset:0
    ds_read_b128 v[140:143], v57 offset:1024
    ds_read_b128 v[144:147], v57 offset:2048
    ds_read_b128 v[148:151], v57 offset:3072
    ds_read_b128 v[152:155], v57 offset:4096
    v_pk_add_f32 v[68:69], v[68:69], v[208:209]
    v_pk_add_f32 v[70:71], v[70:71], v[210:211]
    v_pk_add_f32 v[76:77], v[76:77], v[212:213]
    v_pk_add_f32 v[78:79], v[78:79], v[214:215]
    v_pk_add_f32 v[84:85], v[84:85], v[216:217]
    v_pk_add_f32 v[86:87], v[86:87], v[218:219]
    v_pk_add_f32 v[92:93], v[92:93], v[220:221]
    v_pk_add_f32 v[94:95], v[94:95], v[222:223]
    v_pk_add_f32 v[100:101], v[100:101], v[224:225]
    v_pk_add_f32 v[102:103], v[102:103], v[226:227]
    s_waitcnt lgkmcnt(4)
    v_pk_add_f32 v[68:69], v[68:69], v[136:137]
    v_pk_add_f32 v[70:71], v[70:71], v[138:139]
    v_cvt_pk_bf16_f32 v68, v68, v69
    v_cvt_pk_bf16_f32 v69, v70, v71
    buffer_store_dwordx2 v[68:69], v56, s[52:55], 0 offen offset:0
    s_waitcnt lgkmcnt(3)
    v_pk_add_f32 v[76:77], v[76:77], v[140:141]
    v_pk_add_f32 v[78:79], v[78:79], v[142:143]
    v_cvt_pk_bf16_f32 v76, v76, v77
    v_cvt_pk_bf16_f32 v77, v78, v79
    buffer_store_dwordx2 v[76:77], v56, s[52:55], 0 offen offset:32
    s_waitcnt lgkmcnt(2)
    v_pk_add_f32 v[84:85], v[84:85], v[144:145]
    v_pk_add_f32 v[86:87], v[86:87], v[146:147]
    v_cvt_pk_bf16_f32 v84, v84, v85
    v_cvt_pk_bf16_f32 v85, v86, v87
    buffer_store_dwordx2 v[84:85], v56, s[52:55], 0 offen offset:64
    s_waitcnt lgkmcnt(1)
    v_pk_add_f32 v[92:93], v[92:93], v[148:149]
    v_pk_add_f32 v[94:95], v[94:95], v[150:151]
    v_cvt_pk_bf16_f32 v92, v92, v93
    v_cvt_pk_bf16_f32 v93, v94, v95
    buffer_store_dwordx2 v[92:93], v56, s[52:55], 0 offen offset:96
    s_waitcnt lgkmcnt(0)
    v_pk_add_f32 v[100:101], v[100:101], v[152:153]
    v_pk_add_f32 v[102:103], v[102:103], v[154:155]
    v_cvt_pk_bf16_f32 v100, v100, v101
    v_cvt_pk_bf16_f32 v101, v102, v103
    buffer_store_dwordx2 v[100:101], v56, s[52:55], 0 offen offset:128
    s_nop 7
Lsele_1060:
    s_endpgm
Larare_1051:
    s_cmp_eq_u32 s88, 7
    s_cbranch_scc1 Lan2_1045
    s_cmp_eq_u32 s88, 8
    s_cbranch_scc1 Lan1_1046
    v_mfma_f32_32x32x16_bf16 v[112:127], v[80:83], v[64:67], 0
    v_mfma_f32_32x32x16_bf16 v[112:127], v[84:87], v[68:71], v[112:127]
    ds_read_b64 v[80:81], v34 offset:5376
    ds_read_b64 v[82:83], v34 offset:5384
    ds_read_b64 v[84:85], v35 offset:5408
    ds_read_b64_tr_b16 v[96:97], v36 offset:0
    ds_read_b64_tr_b16 v[98:99], v36 offset:1344
    ds_read_b64_tr_b16 v[100:101], v36 offset:2688
    ds_read_b64_tr_b16 v[102:103], v36 offset:4032
    s_waitcnt lgkmcnt(7)
    v_mfma_f32_32x32x16_bf16 v[128:143], v[88:91], v[72:75], 0
    ds_read_b64 v[88:89], v34 offset:5416
    ds_read_b64 v[90:91], v34 offset:5424
    s_nop 0
    v_exp_f32 v112, v112
    v_exp_f32 v113, v113
    v_exp_f32 v114, v114
    v_exp_f32 v115, v115
    v_mfma_f32_32x32x16_bf16 v[128:143], v[92:95], v[76:79], v[128:143]
    ds_read_b64 v[92:93], v35 offset:5448
    v_exp_f32 v116, v116
    v_exp_f32 v117, v117
    v_exp_f32 v118, v118
    v_exp_f32 v119, v119
    ds_read_b64_tr_b16 v[104:105], v37 offset:0
    ds_read_b64_tr_b16 v[106:107], v37 offset:1344
    v_exp_f32 v120, v120
    v_exp_f32 v121, v121
    v_exp_f32 v122, v122
    v_exp_f32 v123, v123
    ds_read_b64_tr_b16 v[108:109], v37 offset:2688
    ds_read_b64_tr_b16 v[110:111], v37 offset:4032
    v_exp_f32 v124, v124
    v_exp_f32 v125, v125
    v_exp_f32 v126, v126
    v_exp_f32 v127, v127
    v_cvt_pk_bf16_f32 v144, v112, v113
    v_cvt_pk_bf16_f32 v145, v114, v115
    v_cvt_pk_bf16_f32 v146, v116, v117
    v_cvt_pk_bf16_f32 v147, v118, v119
    v_cvt_pk_bf16_f32 v148, v120, v121
    v_cvt_pk_bf16_f32 v149, v122, v123
    v_cvt_pk_bf16_f32 v150, v124, v125
    v_cvt_pk_bf16_f32 v151, v126, v127
    s_waitcnt lgkmcnt(7)
    v_mfma_f32_32x32x16_bf16 v[112:127], v[80:83], v[64:67], 0
    ds_read_b64 v[80:81], v34 offset:10752
    ds_read_b64 v[82:83], v34 offset:10760
    v_exp_f32 v128, v128
    v_exp_f32 v129, v129
    v_exp_f32 v130, v130
    v_exp_f32 v131, v131
    v_mfma_f32_32x32x16_bf16 v[112:127], v[84:87], v[68:71], v[112:127]
    ds_read_b64 v[84:85], v35 offset:10784
    v_exp_f32 v132, v132
    v_exp_f32 v133, v133
    v_exp_f32 v134, v134
    v_exp_f32 v135, v135
    v_mfma_f32_32x32x16_bf16 v[208:223], v[96:99], v[144:147], v[208:223]
    ds_read_b64_tr_b16 v[96:97], v36 offset:5376
    ds_read_b64_tr_b16 v[98:99], v36 offset:6720
    v_exp_f32 v136, v136
    v_exp_f32 v137, v137
    v_exp_f32 v138, v138
    v_exp_f32 v139, v139
    v_mfma_f32_32x32x16_bf16 v[208:223], v[100:103], v[148:151], v[208:223]
    ds_read_b64_tr_b16 v[100:101], v36 offset:8064
    ds_read_b64_tr_b16 v[102:103], v36 offset:9408
    v_exp_f32 v140, v140
    v_exp_f32 v141, v141
    v_exp_f32 v142, v142
    v_exp_f32 v143, v143
    v_cvt_pk_bf16_f32 v152, v128, v129
    v_cvt_pk_bf16_f32 v153, v130, v131
    v_cvt_pk_bf16_f32 v154, v132, v133
    v_cvt_pk_bf16_f32 v155, v134, v135
    v_cvt_pk_bf16_f32 v156, v136, v137
    v_cvt_pk_bf16_f32 v157, v138, v139
    v_cvt_pk_bf16_f32 v158, v140, v141
    v_cvt_pk_bf16_f32 v159, v142, v143
    v_add_u32 v34, 5376, v34
    v_add_u32 v35, 5376, v35
    v_add_u32 v36, 5376, v36
    v_add_u32 v37, 5376, v37
    s_sub_u32 s81, 6, s88
    s_cmp_eq_u32 s81, 0
    s_cbranch_scc1 Lapre_1048
    s_branch Lamid_1047
Lan2_1045:
    v_mfma_f32_32x32x16_bf16 v[112:127], v[80:83], v[64:67], 0
    v_mfma_f32_32x32x16_bf16 v[112:127], v[84:87], v[68:71], v[112:127]
    ds_read_b64 v[80:81], v34 offset:5376
    ds_read_b64 v[82:83], v34 offset:5384
    ds_read_b64 v[84:85], v35 offset:5408
    ds_read_b64_tr_b16 v[96:97], v36 offset:0
    ds_read_b64_tr_b16 v[98:99], v36 offset:1344
    ds_read_b64_tr_b16 v[100:101], v36 offset:2688
    ds_read_b64_tr_b16 v[102:103], v36 offset:4032
    s_waitcnt lgkmcnt(7)
    v_mfma_f32_32x32x16_bf16 v[128:143], v[88:91], v[72:75], 0
    ds_read_b64 v[88:89], v34 offset:5416
    ds_read_b64 v[90:91], v34 offset:5424
    s_nop 0
    v_exp_f32 v112, v112
    v_exp_f32 v113, v113
    v_exp_f32 v114, v114
    v_exp_f32 v115, v115
    v_mfma_f32_32x32x16_bf16 v[128:143], v[92:95], v[76:79], v[128:143]
    ds_read_b64 v[92:93], v35 offset:5448
    v_exp_f32 v116, v116
    v_exp_f32 v117, v117
    v_exp_f32 v118, v118
    v_exp_f32 v119, v119
    ds_read_b64_tr_b16 v[104:105], v37 offset:0
    ds_read_b64_tr_b16 v[106:107], v37 offset:1344
    v_exp_f32 v120, v120
    v_exp_f32 v121, v121
    v_exp_f32 v122, v122
    v_exp_f32 v123, v123
    ds_read_b64_tr_b16 v[108:109], v37 offset:2688
    ds_read_b64_tr_b16 v[110:111], v37 offset:4032
    v_exp_f32 v124, v124
    v_exp_f32 v125, v125
    v_exp_f32 v126, v126
    v_exp_f32 v127, v127
    v_cvt_pk_bf16_f32 v144, v112, v113
    v_cvt_pk_bf16_f32 v145, v114, v115
    v_cvt_pk_bf16_f32 v146, v116, v117
    v_cvt_pk_bf16_f32 v147, v118, v119
    v_cvt_pk_bf16_f32 v148, v120, v121
    v_cvt_pk_bf16_f32 v149, v122, v123
    v_cvt_pk_bf16_f32 v150, v124, v125
    v_cvt_pk_bf16_f32 v151, v126, v127
    s_waitcnt lgkmcnt(7)
    v_mfma_f32_32x32x16_bf16 v[112:127], v[80:83], v[64:67], v[18:33]
    ds_read_b64 v[80:81], v34 offset:10752
    ds_read_b64 v[82:83], v34 offset:10760
    v_exp_f32 v128, v128
    v_exp_f32 v129, v129
    v_exp_f32 v130, v130
    v_exp_f32 v131, v131
    v_mfma_f32_32x32x16_bf16 v[112:127], v[84:87], v[68:71], v[112:127]
    ds_read_b64 v[84:85], v35 offset:10784
    v_exp_f32 v132, v132
    v_exp_f32 v133, v133
    v_exp_f32 v134, v134
    v_exp_f32 v135, v135
    v_mfma_f32_32x32x16_bf16 v[208:223], v[96:99], v[144:147], v[208:223]
    ds_read_b64_tr_b16 v[96:97], v36 offset:5376
    ds_read_b64_tr_b16 v[98:99], v36 offset:6720
    v_exp_f32 v136, v136
    v_exp_f32 v137, v137
    v_exp_f32 v138, v138
    v_exp_f32 v139, v139
    v_mfma_f32_32x32x16_bf16 v[208:223], v[100:103], v[148:151], v[208:223]
    ds_read_b64_tr_b16 v[100:101], v36 offset:8064
    ds_read_b64_tr_b16 v[102:103], v36 offset:9408
    v_exp_f32 v140, v140
    v_exp_f32 v141, v141
    v_exp_f32 v142, v142
    v_exp_f32 v143, v143
    v_cvt_pk_bf16_f32 v152, v128, v129
    v_cvt_pk_bf16_f32 v153, v130, v131
    v_cvt_pk_bf16_f32 v154, v132, v133
    v_cvt_pk_bf16_f32 v155, v134, v135
    v_cvt_pk_bf16_f32 v156, v136, v137
    v_cvt_pk_bf16_f32 v157, v138, v139
    v_cvt_pk_bf16_f32 v158, v140, v141
    v_cvt_pk_bf16_f32 v159, v142, v143
    v_add_u32 v34, 5376, v34
    v_add_u32 v35, 5376, v35
    v_add_u32 v36, 5376, v36
    v_add_u32 v37, 5376, v37
    s_branch Lalast_1049
Lan1_1046:
    v_mfma_f32_32x32x16_bf16 v[112:127], v[80:83], v[64:67], v[18:33]
    v_mfma_f32_32x32x16_bf16 v[112:127], v[84:87], v[68:71], v[112:127]
    ds_read_b64 v[80:81], v34 offset:5376
    ds_read_b64 v[82:83], v34 offset:5384
    ds_read_b64 v[84:85], v35 offset:5408
    ds_read_b64_tr_b16 v[96:97], v36 offset:0
    ds_read_b64_tr_b16 v[98:99], v36 offset:1344
    ds_read_b64_tr_b16 v[100:101], v36 offset:2688
    ds_read_b64_tr_b16 v[102:103], v36 offset:4032
    s_waitcnt lgkmcnt(7)
    v_mfma_f32_32x32x16_bf16 v[128:143], v[88:91], v[72:75], v[18:33]
    s_nop 2
    v_exp_f32 v112, v112
    v_exp_f32 v113, v113
    v_exp_f32 v114, v114
    v_exp_f32 v115, v115
    v_mfma_f32_32x32x16_bf16 v[128:143], v[92:95], v[76:79], v[128:143]
    v_exp_f32 v116, v116
    v_exp_f32 v117, v117
    v_exp_f32 v118, v118
    v_exp_f32 v119, v119
    ds_read_b64_tr_b16 v[104:105], v37 offset:0
    ds_read_b64_tr_b16 v[106:107], v37 offset:1344
    v_exp_f32 v120, v120
    v_exp_f32 v121, v121
    v_exp_f32 v122, v122
    v_exp_f32 v123, v123
    ds_read_b64_tr_b16 v[108:109], v37 offset:2688
    ds_read_b64_tr_b16 v[110:111], v37 offset:4032
    v_exp_f32 v124, v124
    v_exp_f32 v125, v125
    v_exp_f32 v126, v126
    v_exp_f32 v127, v127
    v_cvt_pk_bf16_f32 v144, v112, v113
    v_cvt_pk_bf16_f32 v145, v114, v115
    v_cvt_pk_bf16_f32 v146, v116, v117
    v_cvt_pk_bf16_f32 v147, v118, v119
    v_cvt_pk_bf16_f32 v148, v120, v121
    v_cvt_pk_bf16_f32 v149, v122, v123
    v_cvt_pk_bf16_f32 v150, v124, v125
    v_cvt_pk_bf16_f32 v151, v126, v127
    s_waitcnt lgkmcnt(4)
    v_exp_f32 v128, v128
    v_exp_f32 v129, v129
    v_exp_f32 v130, v130
    v_exp_f32 v131, v131
    v_exp_f32 v132, v132
    v_exp_f32 v133, v133
    v_exp_f32 v134, v134
    v_exp_f32 v135, v135
    v_mfma_f32_32x32x16_bf16 v[208:223], v[96:99], v[144:147], v[208:223]
    v_exp_f32 v136, v136
    v_exp_f32 v137, v137
    v_exp_f32 v138, v138
    v_exp_f32 v139, v139
    v_mfma_f32_32x32x16_bf16 v[208:223], v[100:103], v[148:151], v[208:223]
    v_exp_f32 v140, v140
    v_exp_f32 v141, v141
    v_exp_f32 v142, v142
    v_exp_f32 v143, v143
    v_cvt_pk_bf16_f32 v152, v128, v129
    v_cvt_pk_bf16_f32 v153, v130, v131
    v_cvt_pk_bf16_f32 v154, v132, v133
    v_cvt_pk_bf16_f32 v155, v134, v135
    v_cvt_pk_bf16_f32 v156, v136, v137
    v_cvt_pk_bf16_f32 v157, v138, v139
    v_cvt_pk_bf16_f32 v158, v140, v141
    v_cvt_pk_bf16_f32 v159, v142, v143
    s_waitcnt lgkmcnt(0)
    v_mfma_f32_32x32x16_bf16 v[224:239], v[104:107], v[152:155], v[224:239]
    v_mfma_f32_32x32x16_bf16 v[224:239], v[108:111], v[156:159], v[224:239]
    s_branch Ladone_1050
Lfallback_1052:
    v_and_b32 v192, 31, v0
    s_lshl_b32 s86, s69, 5
    v_add_u32 v193, s86, v192
    v_mul_u32_u24 v193, 168, v193
    v_add_u32 v35, 73728, v193
    v_lshrrev_b32 v194, 5, v0
    v_lshl_add_u32 v34, v194, 4, v35
    v_and_b32 v192, 15, v0
    v_lshrrev_b32 v193, 2, v192
    v_lshl_add_u32 v193, v194, 2, v193
    v_add_u32 v193, s86, v193
    v_mul_u32_u24 v193, 168, v193
    v_add_u32 v193, 73728, v193
    v_and_b32 v195, 3, v0
    v_lshlrev_b32 v196, 3, v195
    v_add_u32 v196, 80, v196
    v_bfe_u32 v197, v0, 4, 1
    v_cmp_eq_u32 vcc, 0, v195
    v_mov_b32 v198, 160
    v_mov_b32 v199, 112
    v_cndmask_b32 v199, v198, v199, vcc
    v_cmp_eq_u32 vcc, 0, v197
    s_nop 1
    v_cndmask_b32 v199, v199, v196, vcc
    v_add_u32 v36, v193, v199
    v_add_u32 v196, 40, v196
    v_cmp_eq_u32 vcc, 0, v195
    v_mov_b32 v199, 152
    s_nop 0
    v_cndmask_b32 v199, v198, v199, vcc
    v_cmp_eq_u32 vcc, 0, v197
    s_nop 1
    v_cndmask_b32 v199, v199, v196, vcc
    v_add_u32 v37, v193, v199
    v_and_b32 v192, 31, v0
    v_lshlrev_b32 v193, 2, v194
    v_sub_u32 v192, v192, v193
    v_mov_b32 v195, 0xf149f2ca
    v_cmp_gt_i32 vcc, 0, v192
    s_nop 1
    v_cndmask_b32 v2, v195, 0, vcc
    v_cndmask_b32 v18, 0, v195, vcc
    v_cmp_gt_i32 vcc, 1, v192
    s_nop 1
    v_cndmask_b32 v3, v195, 0, vcc
    v_cndmask_b32 v19, 0, v195, vcc
    v_cmp_gt_i32 vcc, 2, v192
    s_nop 1
    v_cndmask_b32 v4, v195, 0, vcc
    v_cndmask_b32 v20, 0, v195, vcc
    v_cmp_gt_i32 vcc, 3, v192
    s_nop 1
    v_cndmask_b32 v5, v195, 0, vcc
    v_cndmask_b32 v21, 0, v195, vcc
    v_cmp_gt_i32 vcc, 8, v192
    s_nop 1
    v_cndmask_b32 v6, v195, 0, vcc
    v_cndmask_b32 v22, 0, v195, vcc
    v_cmp_gt_i32 vcc, 9, v192
    s_nop 1
    v_cndmask_b32 v7, v195, 0, vcc
    v_cndmask_b32 v23, 0, v195, vcc
    v_cmp_gt_i32 vcc, 10, v192
    s_nop 1
    v_cndmask_b32 v8, v195, 0, vcc
    v_cndmask_b32 v24, 0, v195, vcc
    v_cmp_gt_i32 vcc, 11, v192
    s_nop 1
    v_cndmask_b32 v9, v195, 0, vcc
    v_cndmask_b32 v25, 0, v195, vcc
    v_cmp_gt_i32 vcc, 16, v192
    s_nop 1
    v_cndmask_b32 v10, v195, 0, vcc
    v_cndmask_b32 v26, 0, v195, vcc
    v_cmp_gt_i32 vcc, 17, v192
    s_nop 1
    v_cndmask_b32 v11, v195, 0, vcc
    v_cndmask_b32 v27, 0, v195, vcc
    v_cmp_gt_i32 vcc, 18, v192
    s_nop 1
    v_cndmask_b32 v12, v195, 0, vcc
    v_cndmask_b32 v28, 0, v195, vcc
    v_cmp_gt_i32 vcc, 19, v192
    s_nop 1
    v_cndmask_b32 v13, v195, 0, vcc
    v_cndmask_b32 v29, 0, v195, vcc
    v_cmp_gt_i32 vcc, 24, v192
    s_nop 1
    v_cndmask_b32 v14, v195, 0, vcc
    v_cndmask_b32 v30, 0, v195, vcc
    v_cmp_gt_i32 vcc, 25, v192
    s_nop 1
    v_cndmask_b32 v15, v195, 0, vcc
    v_cndmask_b32 v31, 0, v195, vcc
    v_cmp_gt_i32 vcc, 26, v192
    s_nop 1
    v_cndmask_b32 v16, v195, 0, vcc
    v_cndmask_b32 v32, 0, v195, vcc
    v_cmp_gt_i32 vcc, 27, v192
    s_nop 1
    v_cndmask_b32 v17, v195, 0, vcc
    v_cndmask_b32 v33, 0, v195, vcc
    v_mov_b32 v239, 0
    v_mov_b32 v238, 0
    v_mov_b32 v237, 0
    v_mov_b32 v236, 0
    v_mov_b32 v235, 0
    v_mov_b32 v234, 0
    v_mov_b32 v233, 0
    v_mov_b32 v232, 0
    v_mov_b32 v231, 0
    v_mov_b32 v230, 0
    v_mov_b32 v229, 0
    v_mov_b32 v228, 0
    v_mov_b32 v227, 0
    v_mov_b32 v226, 0
    v_mov_b32 v225, 0
    v_mov_b32 v224, 0
    v_mov_b32 v223, 0
    v_mov_b32 v222, 0
    v_mov_b32 v221, 0
    v_mov_b32 v220, 0
    v_mov_b32 v219, 0
    v_mov_b32 v218, 0
    v_mov_b32 v217, 0
    v_mov_b32 v216, 0
    v_mov_b32 v215, 0
    v_mov_b32 v214, 0
    v_mov_b32 v213, 0
    v_mov_b32 v212, 0
    v_mov_b32 v211, 0
    v_mov_b32 v210, 0
    v_mov_b32 v209, 0
    v_mov_b32 v208, 0
    s_lshl_b32 s86, s70, 2
    s_add_u32 s86, s86, s69
    s_cmp_ge_u32 s86, 8
    s_cselect_b32 s86, 8, s86
    s_sub_u32 s81, 8, s86
    v_mov_b32 v200, 0xff61b1e6
    v_mov_b32 v201, 0xff61b1e6
    s_mul_i32 s87, s81, 5376
    v_add_u32 v34, s87, v34
    v_add_u32 v35, s87, v35
    v_add_u32 v36, s87, v36
    v_add_u32 v37, s87, v37
Lfb_1061:
    ds_read_b64 v[80:81], v34 offset:0
    ds_read_b64 v[82:83], v34 offset:8
    ds_read_b64 v[84:85], v35 offset:32
    ds_read_b64_tr_b16 v[96:97], v36 offset:0
    ds_read_b64_tr_b16 v[98:99], v36 offset:1344
    ds_read_b64_tr_b16 v[100:101], v36 offset:2688
    ds_read_b64_tr_b16 v[102:103], v36 offset:4032
    ds_read_b64 v[88:89], v34 offset:40
    ds_read_b64 v[90:91], v34 offset:48
    ds_read_b64 v[92:93], v35 offset:72
    ds_read_b64_tr_b16 v[104:105], v37 offset:0
    ds_read_b64_tr_b16 v[106:107], v37 offset:1344
    ds_read_b64_tr_b16 v[108:109], v37 offset:2688
    ds_read_b64_tr_b16 v[110:111], v37 offset:4032
    v_add_u32 v34, 5376, v34
    v_add_u32 v35, 5376, v35
    v_add_u32 v36, 5376, v36
    v_add_u32 v37, 5376, v37
    s_waitcnt lgkmcnt(0)
    v_mfma_f32_32x32x16_bf16 v[112:127], v[80:83], v[64:67], 0
    v_mfma_f32_32x32x16_bf16 v[112:127], v[84:87], v[68:71], v[112:127]
    v_mfma_f32_32x32x16_bf16 v[128:143], v[88:91], v[72:75], 0
    v_mfma_f32_32x32x16_bf16 v[128:143], v[92:95], v[76:79], v[128:143]
    s_nop 15
    s_cmp_lg_u32 s81, 0
    s_cbranch_scc1 Lfbnf_1062
    v_add_f32 v112, v112, v2
    v_add_f32 v113, v113, v3
    v_add_f32 v114, v114, v4
    v_add_f32 v115, v115, v5
    v_add_f32 v116, v116, v6
    v_add_f32 v117, v117, v7
    v_add_f32 v118, v118, v8
    v_add_f32 v119, v119, v9
    v_add_f32 v120, v120, v10
    v_add_f32 v121, v121, v11
    v_add_f32 v122, v122, v12
    v_add_f32 v123, v123, v13
    v_add_f32 v124, v124, v14
    v_add_f32 v125, v125, v15
    v_add_f32 v126, v126, v16
    v_add_f32 v127, v127, v17
    v_add_f32 v128, v128, v2
    v_add_f32 v129, v129, v3
    v_add_f32 v130, v130, v4
    v_add_f32 v131, v131, v5
    v_add_f32 v132, v132, v6
    v_add_f32 v133, v133, v7
    v_add_f32 v134, v134, v8
    v_add_f32 v135, v135, v9
    v_add_f32 v136, v136, v10
    v_add_f32 v137, v137, v11
    v_add_f32 v138, v138, v12
    v_add_f32 v139, v139, v13
    v_add_f32 v140, v140, v14
    v_add_f32 v141, v141, v15
    v_add_f32 v142, v142, v16
    v_add_f32 v143, v143, v17
Lfbnf_1062:
    s_cmp_lg_u32 s81, 8
    s_cbranch_scc1 Lfbnd_1063
    v_add_f32 v112, v112, v18
    v_add_f32 v113, v113, v19
    v_add_f32 v114, v114, v20
    v_add_f32 v115, v115, v21
    v_add_f32 v116, v116, v22
    v_add_f32 v117, v117, v23
    v_add_f32 v118, v118, v24
    v_add_f32 v119, v119, v25
    v_add_f32 v120, v120, v26
    v_add_f32 v121, v121, v27
    v_add_f32 v122, v122, v28
    v_add_f32 v123, v123, v29
    v_add_f32 v124, v124, v30
    v_add_f32 v125, v125, v31
    v_add_f32 v126, v126, v32
    v_add_f32 v127, v127, v33
    v_add_f32 v128, v128, v18
    v_add_f32 v129, v129, v19
    v_add_f32 v130, v130, v20
    v_add_f32 v131, v131, v21
    v_add_f32 v132, v132, v22
    v_add_f32 v133, v133, v23
    v_add_f32 v134, v134, v24
    v_add_f32 v135, v135, v25
    v_add_f32 v136, v136, v26
    v_add_f32 v137, v137, v27
    v_add_f32 v138, v138, v28
    v_add_f32 v139, v139, v29
    v_add_f32 v140, v140, v30
    v_add_f32 v141, v141, v31
    v_add_f32 v142, v142, v32
    v_add_f32 v143, v143, v33
Lfbnd_1063:
    v_max3_f32 v202, v112, v113, v200
    v_max3_f32 v202, v114, v115, v202
    v_max3_f32 v202, v116, v117, v202
    v_max3_f32 v202, v118, v119, v202
    v_max3_f32 v202, v120, v121, v202
    v_max3_f32 v202, v122, v123, v202
    v_max3_f32 v202, v124, v125, v202
    v_max3_f32 v202, v126, v127, v202
    v_mov_b32 v203, v202
    v_mov_b32 v204, v202
    v_nop
    s_nop 0
    v_permlane32_swap_b32 v203, v204
    v_max_f32 v202, v203, v204
    v_sub_f32 v203, v200, v202
    v_exp_f32 v203, v203
    v_mov_b32 v200, v202
    v_sub_f32 v112, v112, v202
    v_sub_f32 v113, v113, v202
    v_sub_f32 v114, v114, v202
    v_sub_f32 v115, v115, v202
    v_sub_f32 v116, v116, v202
    v_sub_f32 v117, v117, v202
    v_sub_f32 v118, v118, v202
    v_sub_f32 v119, v119, v202
    v_sub_f32 v120, v120, v202
    v_sub_f32 v121, v121, v202
    v_sub_f32 v122, v122, v202
    v_sub_f32 v123, v123, v202
    v_sub_f32 v124, v124, v202
    v_sub_f32 v125, v125, v202
    v_sub_f32 v126, v126, v202
    v_sub_f32 v127, v127, v202
    v_mul_f32 v208, v208, v203
    v_mul_f32 v209, v209, v203
    v_mul_f32 v210, v210, v203
    v_mul_f32 v211, v211, v203
    v_mul_f32 v212, v212, v203
    v_mul_f32 v213, v213, v203
    v_mul_f32 v214, v214, v203
    v_mul_f32 v215, v215, v203
    v_mul_f32 v216, v216, v203
    v_mul_f32 v217, v217, v203
    v_mul_f32 v218, v218, v203
    v_mul_f32 v219, v219, v203
    v_mul_f32 v220, v220, v203
    v_mul_f32 v221, v221, v203
    v_mul_f32 v222, v222, v203
    v_mul_f32 v223, v223, v203
    v_exp_f32 v112, v112
    v_exp_f32 v113, v113
    v_exp_f32 v114, v114
    v_exp_f32 v115, v115
    v_exp_f32 v116, v116
    v_exp_f32 v117, v117
    v_exp_f32 v118, v118
    v_exp_f32 v119, v119
    v_exp_f32 v120, v120
    v_exp_f32 v121, v121
    v_exp_f32 v122, v122
    v_exp_f32 v123, v123
    v_exp_f32 v124, v124
    v_exp_f32 v125, v125
    v_exp_f32 v126, v126
    v_exp_f32 v127, v127
    v_cvt_pk_bf16_f32 v144, v112, v113
    v_cvt_pk_bf16_f32 v145, v114, v115
    v_cvt_pk_bf16_f32 v146, v116, v117
    v_cvt_pk_bf16_f32 v147, v118, v119
    v_cvt_pk_bf16_f32 v148, v120, v121
    v_cvt_pk_bf16_f32 v149, v122, v123
    v_cvt_pk_bf16_f32 v150, v124, v125
    v_cvt_pk_bf16_f32 v151, v126, v127
    v_mfma_f32_32x32x16_bf16 v[208:223], v[96:99], v[144:147], v[208:223]
    s_nop 0
    v_mfma_f32_32x32x16_bf16 v[208:223], v[100:103], v[148:151], v[208:223]
    v_max3_f32 v202, v128, v129, v201
    v_max3_f32 v202, v130, v131, v202
    v_max3_f32 v202, v132, v133, v202
    v_max3_f32 v202, v134, v135, v202
    v_max3_f32 v202, v136, v137, v202
    v_max3_f32 v202, v138, v139, v202
    v_max3_f32 v202, v140, v141, v202
    v_max3_f32 v202, v142, v143, v202
    v_mov_b32 v203, v202
    v_mov_b32 v204, v202
    v_nop
    s_nop 0
    v_permlane32_swap_b32 v203, v204
    v_max_f32 v202, v203, v204
    v_sub_f32 v203, v201, v202
    v_exp_f32 v203, v203
    v_mov_b32 v201, v202
    v_sub_f32 v128, v128, v202
    v_sub_f32 v129, v129, v202
    v_sub_f32 v130, v130, v202
    v_sub_f32 v131, v131, v202
    v_sub_f32 v132, v132, v202
    v_sub_f32 v133, v133, v202
    v_sub_f32 v134, v134, v202
    v_sub_f32 v135, v135, v202
    v_sub_f32 v136, v136, v202
    v_sub_f32 v137, v137, v202
    v_sub_f32 v138, v138, v202
    v_sub_f32 v139, v139, v202
    v_sub_f32 v140, v140, v202
    v_sub_f32 v141, v141, v202
    v_sub_f32 v142, v142, v202
    v_sub_f32 v143, v143, v202
    v_mul_f32 v224, v224, v203
    v_mul_f32 v225, v225, v203
    v_mul_f32 v226, v226, v203
    v_mul_f32 v227, v227, v203
    v_mul_f32 v228, v228, v203
    v_mul_f32 v229, v229, v203
    v_mul_f32 v230, v230, v203
    v_mul_f32 v231, v231, v203
    v_mul_f32 v232, v232, v203
    v_mul_f32 v233, v233, v203
    v_mul_f32 v234, v234, v203
    v_mul_f32 v235, v235, v203
    v_mul_f32 v236, v236, v203
    v_mul_f32 v237, v237, v203
    v_mul_f32 v238, v238, v203
    v_mul_f32 v239, v239, v203
    v_exp_f32 v128, v128
    v_exp_f32 v129, v129
    v_exp_f32 v130, v130
    v_exp_f32 v131, v131
    v_exp_f32 v132, v132
    v_exp_f32 v133, v133
    v_exp_f32 v134, v134
    v_exp_f32 v135, v135
    v_exp_f32 v136, v136
    v_exp_f32 v137, v137
    v_exp_f32 v138, v138
    v_exp_f32 v139, v139
    v_exp_f32 v140, v140
    v_exp_f32 v141, v141
    v_exp_f32 v142, v142
    v_exp_f32 v143, v143
    v_cvt_pk_bf16_f32 v152, v128, v129
    v_cvt_pk_bf16_f32 v153, v130, v131
    v_cvt_pk_bf16_f32 v154, v132, v133
    v_cvt_pk_bf16_f32 v155, v134, v135
    v_cvt_pk_bf16_f32 v156, v136, v137
    v_cvt_pk_bf16_f32 v157, v138, v139
    v_cvt_pk_bf16_f32 v158, v140, v141
    v_cvt_pk_bf16_f32 v159, v142, v143
    v_mfma_f32_32x32x16_bf16 v[224:239], v[104:107], v[152:155], v[224:239]
    s_nop 0
    v_mfma_f32_32x32x16_bf16 v[224:239], v[108:111], v[156:159], v[224:239]
    s_add_u32 s81, s81, 1
    s_cmp_le_u32 s81, 8
    s_cbranch_scc1 Lfb_1061
    s_nop 15
    v_mov_b32 v194, v216
    v_mov_b32 v192, v216
    v_nop
    s_nop 0
    v_permlane32_swap_b32 v194, v192
    v_mov_b32 v194, v232
    v_mov_b32 v193, v232
    v_nop
    s_nop 0
    v_permlane32_swap_b32 v194, v193
    s_branch Lnorm_1053
parallel_sum__sliding_block__mixer_token_mlp__prompt_kernel_end:
    s_endpgm
parallel_sum__sliding_block__mixer_token_mlp__prompt_kernel_code_end:
.set CODE_BYTES, parallel_sum__sliding_block__mixer_token_mlp__prompt_kernel_code_end-parallel_sum__sliding_block__mixer_token_mlp__prompt_kernel
.section .rodata,"a"
.p2align 6
.amdhsa_kernel parallel_sum__sliding_block__mixer_token_mlp__prompt_kernel
  .amdhsa_next_free_vgpr 256
  .amdhsa_next_free_sgpr 102
  .amdhsa_accum_offset 256
  .amdhsa_group_segment_fixed_size 0
  .amdhsa_kernarg_size 88
  .amdhsa_user_sgpr_count 2
  .amdhsa_user_sgpr_kernarg_segment_ptr 1
  .amdhsa_system_sgpr_workgroup_id_x 1
.end_amdhsa_kernel
```
